```python
import torch

def _softmax(x, axis=-1):
    return torch.softmax(x, dim=axis)
def _gelu(x):
    return torch.nn.functional.gelu(x, approximate="tanh")
def _silu(x):
    return torch.nn.functional.silu(x)
def _sigmoid(x):
    return torch.sigmoid(x)
def _layernorm(x, axis=-1, eps=1e-5):
    m = x.mean(dim=axis, keepdim=True)
    v = x.var(dim=axis, keepdim=True, unbiased=False)
    return (x - m) / torch.sqrt(v + eps)
def _scatter_add(tgt, idx, src, axis=0):
    return tgt.clone().index_add_(axis, idx, src)
def _segment_sum(src, seg, n):
    out = torch.zeros((n,) + src.shape[1:], dtype=src.dtype)
    return out.index_add_(0, seg, src)
def _pad(x, pw):
    flat = tuple(v for pair in reversed(pw) for v in pair)
    return torch.nn.functional.pad(x, flat)

kernel_name = 'parallel_sum__mha_block_cached__dense_activation_relu__decode'

def setup_inputs():

    _w = (lambda a: (lambda t: t.to(torch.bfloat16) if t.is_floating_point() else t)(torch.as_tensor(a)))
    def _A_setup():
        B, Sq, D = 8, 1, 1024
        H, Sk, Dh = 32, 4096, 128
        return {
            "x": _w((lambda *s: torch.randn(*s, dtype=torch.bfloat16) * 0.05)(B, Sq, D)),
            "k_cache": _w((lambda *s: torch.randn(*s, dtype=torch.bfloat16) * 3.2)(B, H, Sk, Dh)),
            "v_cache": _w((lambda *s: torch.randn(*s, dtype=torch.bfloat16) * 1.6)(B, H, Sk, Dh)),
            "wq": _w((lambda *s: torch.randn(*s, dtype=torch.bfloat16) * 3.2)(D, H * Dh) * (D ** -0.5)),
            "wo": _w((lambda *s: torch.randn(*s, dtype=torch.bfloat16) * 1.6)(H * Dh, D) * ((H * Dh) ** -0.5)),
        }
    _A_in = _A_setup()

    def _B_setup():
        B, S, D, Dff = 8, 1, 1024, 3584
        return {
            "x": _w((lambda *s: torch.randn(*s, dtype=torch.bfloat16) * 0.05)(B, S, D)),
            "w1": _w((lambda *s: torch.randn(*s, dtype=torch.bfloat16) * 0.05)(D, Dff)),
            "w2": _w((lambda *s: torch.randn(*s, dtype=torch.bfloat16) * 0.05)(Dff, D)),
        }
    _B_in = _B_setup()

    return {
        "A_x": _A_in["x"],
        "A_k_cache": _A_in["k_cache"],
        "A_v_cache": _A_in["v_cache"],
        "A_wq": _A_in["wq"],
        "A_wo": _A_in["wo"],
        "B_x": _B_in["x"],
        "B_w1": _B_in["w1"],
        "B_w2": _B_in["w2"],
    }

def reference(A_x, A_k_cache, A_v_cache, A_wq, A_wo, B_x, B_w1, B_w2):
    def _A_ref(x, k_cache, v_cache, wq, wo):
        B, Sq, D = x.shape
        H, Dh = 32, 128
        q = (lambda x, *d: x.permute(*d))((x @ wq).reshape(B, Sq, H, Dh), 0, 2, 1, 3)
        scores = torch.einsum("bhqd,bhkd->bhqk", q, k_cache) * (Dh ** -0.5)
        p = _softmax(scores, axis=-1)
        o = torch.einsum("bhqk,bhkd->bhqd", p, v_cache)
        return (lambda x, *d: x.permute(*d))(o, 0, 2, 1, 3).reshape(B, Sq, H * Dh) @ wo

    def _B_ref(x, w1, w2):
        h = torch.einsum("bsd,df->bsf", x, w1)
        zero = torch.zeros_like(h)
        h = torch.maximum(h, zero)
        return torch.einsum("bsf,fd->bsd", h, w2)

    x = A_x
    xn = _layernorm(x, axis=-1)
    return x + _A_ref(xn, A_k_cache, A_v_cache, A_wq, A_wo) + _B_ref(xn, B_w1, B_w2)
```

```asm
; @launch grid=(256,1,1) block=(512,1,1) lds=74240
.amdgcn_target "amdgcn-amd-amdhsa--gfx950"
.text
.globl parallel_sum__mha_block_cached__dense_activation_relu__decode_kernel
.p2align 8
.type parallel_sum__mha_block_cached__dense_activation_relu__decode_kernel,@function
parallel_sum__mha_block_cached__dense_activation_relu__decode_kernel:
    s_cmp_ge_u32 s2, 256
    s_cbranch_scc1 L_done
    s_load_dwordx16 s[4:19], s[0:1], 0
    s_load_dwordx4 s[20:23], s[0:1], 64
    s_load_dwordx2 s[24:25], s[0:1], 80
    v_lshrrev_b32 v1, 6, v0
    v_and_b32 v0, 63, v0
    v_readfirstlane_b32 s3, v1
    v_lshrrev_b32 v38, 4, v0
    v_and_b32 v39, 15, v0
    v_lshlrev_b32 v2, 4, v0
    v_lshlrev_b32 v40, 4, v39
    v_lshl_add_u32 v5, v38, 13, v40
    v_lshl_add_u32 v4, v38, 11, v40
    v_mul_u32_u24 v3, 7168, v38
    v_add_u32 v3, v3, v40
    v_lshlrev_b32 v1, 5, v0
    s_lshr_b32 s26, s2, 5
    s_bfe_u32 s26, s2, 0x30003
    s_and_b32 s27, s2, 7
    s_lshl_b32 s27, s27, 1
    s_bfe_u32 s66, s2, 0x10006
    s_or_b32 s27, s27, s66
    s_bfe_u32 s66, s2, 0x10007
    s_lshl_b32 s66, s66, 4
    s_or_b32 s27, s27, s66
    s_lshl_b32 s68, s26, 5
    s_or_b32 s68, s68, s27
    s_lshl_b32 s68, s68, 20
    s_lshl_b32 s66, s26, 11
    s_lshl_b32 s67, s27, 8
    s_lshl_b32 s69, s3, 8
    s_lshl_b32 s56, s3, 12
    v_add_u32 v4, s69, v4
    s_mul_i32 s57, s26, 0
    s_mov_b32 s58, 28672
    s_mov_b32 s76, 917504
    v_lshlrev_b32 v28, 4, v39
    v_lshlrev_b32 v30, 11, v39
    v_lshl_add_u32 v6, v39, 2, v38
    v_lshlrev_b32 v31, 1, v6
    s_lshl_b32 s74, s26, 8
    s_lshl_b32 s75, s3, 5
    s_add_u32 s74, s74, s75
    s_lshl_b32 s73, s3, 11
    s_lshl_b32 s60, s26, 7
    s_lshl_b32 s75, s3, 4
    s_add_u32 s60, s60, s75
    s_lshl_b32 s60, s60, 13
    s_waitcnt lgkmcnt(0)
    s_load_dwordx2 s[96:97], s[24:25], 131072
    s_mov_b32 s52, s4
    s_mov_b32 s53, s5
    s_mov_b32 s54, 16384
    s_mov_b32 s55, 0x20000
    s_add_u32 s40, s4, s66
    s_addc_u32 s41, s5, 0
    s_mov_b32 s42, 2048
    s_mov_b32 s43, 0x20000
    buffer_load_dwordx4 v[40:43], v1, s[52:55], s73 offen
    buffer_load_dwordx4 v[44:47], v1, s[52:55], s73 offen offset:16
    s_barrier
    buffer_load_dwordx4 v[240:243], v30, s[52:55], s74 offen offset:0
    buffer_load_dwordx4 v[244:247], v30, s[52:55], s74 offen offset:16
    s_add_u32 s36, s10, s67
    s_addc_u32 s37, s11, 0
    s_sub_u32 s38, 8388608, s67
    s_mov_b32 s39, 0x20000
    buffer_load_dwordx4 v[192:195], v5, s[36:39], s60 offen nt
    s_add_u32 s60, s60, 32768
    buffer_load_dwordx4 v[196:199], v5, s[36:39], s60 offen nt
    s_add_u32 s60, s60, 32768
    buffer_load_dwordx4 v[200:203], v5, s[36:39], s60 offen nt
    s_add_u32 s60, s60, 32768
    buffer_load_dwordx4 v[204:207], v5, s[36:39], s60 offen nt
    s_add_u32 s28, s6, s68
    s_addc_u32 s29, s7, 0
    s_mov_b32 s30, 0x100000
    s_mov_b32 s31, 0x20000
    s_sub_u32 s71, s27, 16
    s_cmp_lt_u32 s27, 28
    s_cselect_b32 s71, s27, s71
    s_lshl_b32 s74, s71, 8
    s_mul_i32 s75, s3, 917504
    s_add_u32 s75, s75, s74
    s_add_u32 s32, s16, s75
    s_addc_u32 s33, s17, 0
    s_sub_u32 s34, 7340032, s75
    s_mov_b32 s35, 0x20000
    s_mov_b32 s44, s22
    s_mov_b32 s45, s23
    s_mov_b32 s46, 256
    s_mov_b32 s47, 0x20000
    s_lshl_b32 s70, s26, 5
    s_mov_b32 s48, s24
    s_mov_b32 s49, s25
    s_mov_b32 s50, 4194304
    s_mov_b32 s51, 0x20000
    s_mov_b32 s62, 0xcccccccc
    s_mov_b32 s63, 0xcccccccc
    s_mov_b32 s64, 0xaaaaaaaa
    s_mov_b32 s65, 0xaaaaaaaa
    s_mov_b32 s77, 0x05040100
    s_mov_b32 s61, 0x07060302
    v_mov_b32 v32, 0
    s_waitcnt vmcnt(6)
    v_lshlrev_b32 v8, 16, v40
    v_and_b32 v9, 0xffff0000, v40
    v_lshlrev_b32 v10, 16, v41
    v_and_b32 v11, 0xffff0000, v41
    v_lshlrev_b32 v12, 16, v42
    v_and_b32 v13, 0xffff0000, v42
    v_lshlrev_b32 v14, 16, v43
    v_and_b32 v15, 0xffff0000, v43
    v_lshlrev_b32 v16, 16, v44
    v_and_b32 v17, 0xffff0000, v44
    v_lshlrev_b32 v18, 16, v45
    v_and_b32 v19, 0xffff0000, v45
    v_lshlrev_b32 v20, 16, v46
    v_and_b32 v21, 0xffff0000, v46
    v_lshlrev_b32 v22, 16, v47
    v_and_b32 v23, 0xffff0000, v47
    v_add_f32 v40, v8, v9
    v_add_f32 v41, v10, v11
    v_add_f32 v42, v12, v13
    v_add_f32 v43, v14, v15
    v_add_f32 v44, v16, v17
    v_add_f32 v45, v18, v19
    v_add_f32 v46, v20, v21
    v_add_f32 v47, v22, v23
    v_add_f32 v40, v40, v44
    v_add_f32 v41, v41, v45
    v_add_f32 v42, v42, v46
    v_add_f32 v43, v43, v47
    v_add_f32 v40, v40, v42
    v_add_f32 v41, v41, v43
    v_add_f32 v40, v40, v41
    s_nop 1
    v_add_f32_dpp v40, v40, v40 row_ror:8 row_mask:0xf bank_mask:0xf
    s_nop 1
    v_add_f32_dpp v40, v40, v40 row_ror:4 row_mask:0xf bank_mask:0xf
    s_nop 1
    v_add_f32_dpp v40, v40, v40 row_ror:2 row_mask:0xf bank_mask:0xf
    s_nop 1
    v_add_f32_dpp v40, v40, v40 row_ror:1 row_mask:0xf bank_mask:0xf
    v_mov_b32 v41, v40
    s_nop 1
    v_permlane16_swap_b32 v40, v41
    v_add_f32 v40, v40, v41
    v_mov_b32 v41, v40
    s_nop 1
    v_permlane32_swap_b32 v40, v41
    v_add_f32 v40, v40, v41
    v_mul_f32 v42, 0x3a800000, v40
    v_sub_f32 v8, v8, v42
    v_sub_f32 v9, v9, v42
    v_sub_f32 v10, v10, v42
    v_sub_f32 v11, v11, v42
    v_sub_f32 v12, v12, v42
    v_sub_f32 v13, v13, v42
    v_sub_f32 v14, v14, v42
    v_sub_f32 v15, v15, v42
    v_sub_f32 v16, v16, v42
    v_sub_f32 v17, v17, v42
    v_sub_f32 v18, v18, v42
    v_sub_f32 v19, v19, v42
    v_sub_f32 v20, v20, v42
    v_sub_f32 v21, v21, v42
    v_sub_f32 v22, v22, v42
    v_sub_f32 v23, v23, v42
    v_mul_f32 v40, v8, v8
    v_mul_f32 v41, v9, v9
    v_fmac_f32 v40, v10, v10
    v_fmac_f32 v41, v11, v11
    v_fmac_f32 v40, v12, v12
    v_fmac_f32 v41, v13, v13
    v_fmac_f32 v40, v14, v14
    v_fmac_f32 v41, v15, v15
    v_fmac_f32 v40, v16, v16
    v_fmac_f32 v41, v17, v17
    v_fmac_f32 v40, v18, v18
    v_fmac_f32 v41, v19, v19
    v_fmac_f32 v40, v20, v20
    v_fmac_f32 v41, v21, v21
    v_fmac_f32 v40, v22, v22
    v_fmac_f32 v41, v23, v23
    v_add_f32 v40, v40, v41
    s_nop 1
    v_add_f32_dpp v40, v40, v40 row_ror:8 row_mask:0xf bank_mask:0xf
    s_nop 1
    v_add_f32_dpp v40, v40, v40 row_ror:4 row_mask:0xf bank_mask:0xf
    s_nop 1
    v_add_f32_dpp v40, v40, v40 row_ror:2 row_mask:0xf bank_mask:0xf
    s_nop 1
    v_add_f32_dpp v40, v40, v40 row_ror:1 row_mask:0xf bank_mask:0xf
    v_mov_b32 v41, v40
    s_nop 1
    v_permlane16_swap_b32 v40, v41
    v_add_f32 v40, v40, v41
    v_mov_b32 v41, v40
    s_nop 1
    v_permlane32_swap_b32 v40, v41
    v_add_f32 v40, v40, v41
    v_mul_f32 v40, 0x3a800000, v40
    v_cvt_pk_bf16_f32 v40, v40, v40
    v_lshlrev_b32 v40, 16, v40
    v_add_f32 v40, 0x3727c5ac, v40
    v_cvt_pk_bf16_f32 v40, v40, v40
    v_lshlrev_b32 v40, 16, v40
    v_sqrt_f32 v40, v40
    s_nop 0
    v_cvt_pk_bf16_f32 v41, v40, v40
    v_lshlrev_b32 v41, 16, v41
    v_cvt_pk_bf16_f32 v40, v42, v42
    v_lshlrev_b32 v40, 16, v40
    v_rcp_f32 v42, v41
    s_lshl_b32 s75, s3, 4
    v_mov_b32 v44, s75
    v_mov_b32 v43, 0
    ds_write_b128 v44, v[40:43] offset:41216
    s_lshl_b32 s75, s27, 3
    s_add_u32 s75, s75, s3
    s_lshl_b32 s75, s75, 3
    s_add_u32 s75, s75, s26
    s_lshl_b32 s75, s75, 10
    s_add_u32 s75, s75, 2097152
    buffer_load_dwordx4 v[236:239], v2, s[48:51], s75 offen
    buffer_load_ushort v36, v31, s[40:43], s69 offen
    buffer_load_ushort v37, v31, s[40:43], s69 offen offset:128
    buffer_load_dwordx4 v[48:51], v2, s[28:31], s56 offen nt
    buffer_load_dwordx4 v[52:55], v2, s[28:31], s56 offen offset:1024 nt
    s_lshl_b32 s75, s26, 4
    v_mov_b32 v44, s75
    s_lshl_b32 s72, s3, 9
    v_mov_b32 v8, 0
    v_mov_b32 v9, 0
    v_mov_b32 v10, 0
    v_mov_b32 v11, 0
    v_mov_b32 v12, 0
    v_mov_b32 v13, 0
    v_mov_b32 v14, 0
    v_mov_b32 v15, 0
    v_mov_b32 v16, 0
    v_mov_b32 v17, 0
    v_mov_b32 v18, 0
    v_mov_b32 v19, 0
    v_mov_b32 v20, 0
    v_mov_b32 v21, 0
    v_mov_b32 v22, 0
    v_mov_b32 v23, 0
    s_waitcnt lgkmcnt(0)
    s_barrier
    ds_read_b128 v[228:231], v28 offset:41216
    ds_read_b128 v[232:235], v44 offset:41216
    buffer_load_dwordx4 v[56:59], v2, s[28:31], s56 offen offset:2048 nt
    s_waitcnt vmcnt(10)
    v_and_b32 v40, 1, v38
    v_lshlrev_b32 v40, 4, v40
    s_mov_b32 s98, 0
    s_mov_b32 s99, -1
    v_cndmask_b32 v224, v240, v241, s[98:99]
    v_cndmask_b32 v225, v242, v243, s[98:99]
    v_cndmask_b32 v226, v244, v245, s[98:99]
    v_cndmask_b32 v227, v246, v247, s[98:99]
    v_lshrrev_b32 v224, v40, v224
    v_lshrrev_b32 v225, v40, v225
    v_lshrrev_b32 v226, v40, v226
    v_lshrrev_b32 v227, v40, v227
    v_and_b32 v224, 0xffff, v224
    v_and_b32 v225, 0xffff, v225
    v_and_b32 v226, 0xffff, v226
    v_and_b32 v227, 0xffff, v227
    s_waitcnt lgkmcnt(0)
    v_lshlrev_b32 v224, 16, v224
    v_sub_f32 v224, v224, v228
    v_cvt_pk_bf16_f32 v224, v224, v224
    v_lshlrev_b32 v224, 16, v224
    v_mul_f32 v40, v224, v230
    v_fma_f32 v46, -v40, v229, v224
    v_fma_f32 v40, v46, v230, v40
    v_lshlrev_b32 v225, 16, v225
    v_sub_f32 v225, v225, v228
    v_cvt_pk_bf16_f32 v225, v225, v225
    v_lshlrev_b32 v225, 16, v225
    v_mul_f32 v41, v225, v230
    v_fma_f32 v46, -v41, v229, v225
    v_fma_f32 v41, v46, v230, v41
    v_cvt_pk_bf16_f32 v34, v40, v41
    v_lshlrev_b32 v226, 16, v226
    v_sub_f32 v226, v226, v228
    v_cvt_pk_bf16_f32 v226, v226, v226
    v_lshlrev_b32 v226, 16, v226
    v_mul_f32 v40, v226, v230
    v_fma_f32 v46, -v40, v229, v226
    v_fma_f32 v40, v46, v230, v40
    v_lshlrev_b32 v227, 16, v227
    v_sub_f32 v227, v227, v228
    v_cvt_pk_bf16_f32 v227, v227, v227
    v_lshlrev_b32 v227, 16, v227
    v_mul_f32 v41, v227, v230
    v_fma_f32 v46, -v41, v229, v227
    v_fma_f32 v41, v46, v230, v41
    v_cvt_pk_bf16_f32 v35, v40, v41
    buffer_load_dwordx4 v[60:63], v2, s[28:31], s56 offen offset:3072 nt
    s_add_u32 s56, s56, 32768
    s_waitcnt vmcnt(7)
    v_perm_b32 v208, v196, v192, s77
    v_perm_b32 v210, v196, v192, s61
    v_perm_b32 v209, v204, v200, s77
    v_perm_b32 v211, v204, v200, s61
    v_perm_b32 v212, v197, v193, s77
    v_perm_b32 v214, v197, v193, s61
    v_perm_b32 v213, v205, v201, s77
    v_perm_b32 v215, v205, v201, s61
    v_perm_b32 v216, v198, v194, s77
    v_perm_b32 v218, v198, v194, s61
    v_perm_b32 v217, v206, v202, s77
    v_perm_b32 v219, v206, v202, s61
    v_perm_b32 v220, v199, v195, s77
    v_perm_b32 v222, v199, v195, s61
    v_perm_b32 v221, v207, v203, s77
    v_perm_b32 v223, v207, v203, s61
    buffer_load_dwordx4 v[64:67], v3, s[32:35], s57 offen
    s_add_u32 s57, s57, s58
    s_cmp_ge_u32 s57, s76
    s_cselect_b32 s57, 0, s57
    s_nop 1
    v_mfma_f32_16x16x16_bf16 v[128:131], v[208:209], v[34:35], 0
    v_mfma_f32_16x16x16_bf16 v[132:135], v[210:211], v[34:35], 0
    v_mfma_f32_16x16x16_bf16 v[136:139], v[212:213], v[34:35], 0
    v_mfma_f32_16x16x16_bf16 v[140:143], v[214:215], v[34:35], 0
    v_mfma_f32_16x16x16_bf16 v[144:147], v[216:217], v[34:35], 0
    v_mfma_f32_16x16x16_bf16 v[148:151], v[218:219], v[34:35], 0
    v_mfma_f32_16x16x16_bf16 v[152:155], v[220:221], v[34:35], 0
    v_mfma_f32_16x16x16_bf16 v[156:159], v[222:223], v[34:35], 0
    buffer_load_dwordx4 v[68:71], v2, s[28:31], s56 offen nt
    v_lshlrev_b32 v44, 5, v39
    v_lshl_add_u32 v44, v38, 3, v44
    v_add_u32 v45, s72, v44
    s_lshl_b32 s75, s3, 12
    s_add_u32 s75, s75, 41472
    v_lshlrev_b32 v46, 9, v39
    v_lshl_add_u32 v46, v38, 7, v46
    v_add_u32 v46, s75, v46
    s_nop 7
    s_mov_b32 exec_lo, 0x00ff00ff
    s_mov_b32 exec_hi, 0x00ff00ff
    ds_write_b128 v46, v[128:131] offset:0
    ds_write_b128 v46, v[132:135] offset:16
    ds_write_b128 v46, v[136:139] offset:32
    ds_write_b128 v46, v[140:143] offset:48
    ds_write_b128 v46, v[144:147] offset:64
    ds_write_b128 v46, v[148:151] offset:80
    ds_write_b128 v46, v[152:155] offset:96
    ds_write_b128 v46, v[156:159] offset:112
    s_mov_b64 exec, -1
    buffer_load_dwordx4 v[72:75], v2, s[28:31], s56 offen offset:1024 nt
    v_lshlrev_b32 v47, 3, v0
    s_add_u32 s75, s72, 41472
    v_add_u32 v47, s75, v47
    s_waitcnt lgkmcnt(0)
    s_barrier
    ds_read_b64 v[192:193], v47 offset:0
    ds_read_b64 v[194:195], v47 offset:4096
    ds_read_b64 v[196:197], v47 offset:8192
    ds_read_b64 v[198:199], v47 offset:12288
    ds_read_b64 v[200:201], v47 offset:16384
    ds_read_b64 v[202:203], v47 offset:20480
    ds_read_b64 v[204:205], v47 offset:24576
    ds_read_b64 v[206:207], v47 offset:28672
    buffer_load_dwordx4 v[76:79], v2, s[28:31], s56 offen offset:2048 nt
    s_add_u32 s96, s96, 1
    s_addc_u32 s97, s97, 0
    s_lshl_b32 s73, s27, 3
    s_add_u32 s74, s73, s3
    s_lshl_b32 s74, s74, 3
    s_add_u32 s74, s74, s26
    s_lshl_b32 s74, s74, 10
    s_add_u32 s74, s74, 2097152
    s_waitcnt lgkmcnt(0)
    v_add_f32 v192, v192, v200
    v_add_f32 v193, v193, v201
    v_add_f32 v194, v194, v202
    v_add_f32 v195, v195, v203
    v_add_f32 v196, v196, v204
    v_add_f32 v197, v197, v205
    v_add_f32 v198, v198, v206
    v_add_f32 v199, v199, v207
    v_add_f32 v192, v192, v196
    v_add_f32 v193, v193, v197
    v_add_f32 v194, v194, v198
    v_add_f32 v195, v195, v199
    v_add_f32 v192, v192, v194
    v_add_f32 v193, v193, v195
    v_mov_b32 v194, s96
    v_mov_b32 v195, s97
    buffer_store_dwordx4 v[192:195], v2, s[48:51], s74 offen sc1
    s_waitcnt vmcnt(9)
    v_lshlrev_b32 v36, 16, v36
    v_sub_f32 v36, v36, v232
    v_cvt_pk_bf16_f32 v36, v36, v36
    v_lshlrev_b32 v36, 16, v36
    v_mul_f32 v40, v36, v234
    v_fma_f32 v46, -v40, v233, v36
    v_fma_f32 v40, v46, v234, v40
    v_lshlrev_b32 v37, 16, v37
    v_sub_f32 v37, v37, v232
    v_cvt_pk_bf16_f32 v37, v37, v37
    v_lshlrev_b32 v37, 16, v37
    v_mul_f32 v41, v37, v234
    v_fma_f32 v46, -v41, v233, v37
    v_fma_f32 v41, v46, v234, v41
    v_cvt_pk_bf16_f32 v36, v40, 0
    v_cvt_pk_bf16_f32 v37, v41, 0
    s_cmp_lt_u32 s27, 28
    s_cselect_b32 s75, -1, 0
    v_and_b32 v36, s75, v36
    v_and_b32 v37, s75, v37
    v_lshlrev_b32 v43, 2, v6
    v_add_u32 v43, s72, v43
    ds_write_b32 v43, v36 offset:0
    ds_write_b32 v43, v37 offset:256
    s_cmp_lg_u32 s3, 0
    s_cbranch_scc1 L_qoth
    s_lshl_b32 s73, s27, 3
    s_add_u32 s73, s73, s26
    s_lshl_b32 s73, s73, 13
    s_add_u32 s73, s73, 2097152
    s_add_u32 s74, s73, 4096
    s_mov_b32 s75, 0x200000
    s_waitcnt vmcnt(0)
L_qpoll:
    buffer_load_dwordx4 v[128:131], v2, s[48:51], s73 offen offset:0 sc1
    buffer_load_dwordx4 v[132:135], v2, s[48:51], s73 offen offset:1024 sc1
    buffer_load_dwordx4 v[136:139], v2, s[48:51], s73 offen offset:2048 sc1
    buffer_load_dwordx4 v[140:143], v2, s[48:51], s73 offen offset:3072 sc1
    buffer_load_dwordx4 v[144:147], v2, s[48:51], s74 offen offset:0 sc1
    buffer_load_dwordx4 v[148:151], v2, s[48:51], s74 offen offset:1024 sc1
    buffer_load_dwordx4 v[152:155], v2, s[48:51], s74 offen offset:2048 sc1
    buffer_load_dwordx4 v[156:159], v2, s[48:51], s74 offen offset:3072 sc1
    s_waitcnt vmcnt(0)
    v_xor_b32 v46, s96, v130
    v_xor_b32 v41, s97, v131
    v_or_b32 v46, v46, v41
    v_xor_b32 v40, s96, v134
    v_xor_b32 v41, s97, v135
    v_or3_b32 v46, v46, v40, v41
    v_xor_b32 v40, s96, v138
    v_xor_b32 v41, s97, v139
    v_or3_b32 v46, v46, v40, v41
    v_xor_b32 v40, s96, v142
    v_xor_b32 v41, s97, v143
    v_or3_b32 v46, v46, v40, v41
    v_xor_b32 v40, s96, v146
    v_xor_b32 v41, s97, v147
    v_or3_b32 v46, v46, v40, v41
    v_xor_b32 v40, s96, v150
    v_xor_b32 v41, s97, v151
    v_or3_b32 v46, v46, v40, v41
    v_xor_b32 v40, s96, v154
    v_xor_b32 v41, s97, v155
    v_or3_b32 v46, v46, v40, v41
    v_xor_b32 v40, s96, v158
    v_xor_b32 v41, s97, v159
    v_or3_b32 v46, v46, v40, v41
    v_cmp_eq_u32 vcc, 0, v46
    s_nop 1
    s_cmp_eq_u64 vcc, -1
    s_cbranch_scc1 L_qok
    s_sub_u32 s75, s75, 1
    s_cbranch_scc0 L_qpoll
L_qok:
    v_add_f32 v128, v128, v144
    v_add_f32 v129, v129, v145
    v_add_f32 v132, v132, v148
    v_add_f32 v133, v133, v149
    v_add_f32 v136, v136, v152
    v_add_f32 v137, v137, v153
    v_add_f32 v140, v140, v156
    v_add_f32 v141, v141, v157
    v_add_f32 v128, v128, v136
    v_add_f32 v129, v129, v137
    v_add_f32 v132, v132, v140
    v_add_f32 v133, v133, v141
    v_add_f32 v128, v128, v132
    v_add_f32 v129, v129, v133
    v_cvt_pk_bf16_f32 v128, v128, v129
    v_and_b32 v46, 1, v0
    v_lshlrev_b32 v46, 4, v46
    v_lshl_add_u32 v46, v38, 5, v46
    v_lshrrev_b32 v40, 1, v39
    v_add_u32 v46, v46, v40
    v_lshlrev_b32 v46, 1, v46
    ds_write_b16 v46, v128 offset:20480
    ds_write_b16_d16_hi v46, v128 offset:20496
    buffer_load_dwordx4 v[80:83], v2, s[28:31], s56 offen offset:3072 nt
    s_add_u32 s56, s56, 32768
    buffer_load_dwordx4 v[84:87], v3, s[32:35], s57 offen
    s_add_u32 s57, s57, s58
    s_cmp_ge_u32 s57, s76
    s_cselect_b32 s57, 0, s57
    buffer_load_dwordx4 v[88:91], v2, s[28:31], s56 offen nt
    buffer_load_dwordx4 v[92:95], v2, s[28:31], s56 offen offset:1024 nt
    buffer_load_dwordx4 v[96:99], v2, s[28:31], s56 offen offset:2048 nt
    buffer_load_dwordx4 v[100:103], v2, s[28:31], s56 offen offset:3072 nt
    s_add_u32 s56, s56, 32768
    buffer_load_dwordx4 v[104:107], v3, s[32:35], s57 offen
    s_add_u32 s57, s57, s58
    s_cmp_ge_u32 s57, s76
    s_cselect_b32 s57, 0, s57
    buffer_load_dwordx4 v[108:111], v2, s[28:31], s56 offen nt
    s_branch L_qjoin
L_qoth:
    s_waitcnt vmcnt(3)
    buffer_load_dwordx4 v[80:83], v2, s[28:31], s56 offen offset:3072 nt
    s_add_u32 s56, s56, 32768
    s_waitcnt vmcnt(3)
    buffer_load_dwordx4 v[84:87], v3, s[32:35], s57 offen
    s_add_u32 s57, s57, s58
    s_cmp_ge_u32 s57, s76
    s_cselect_b32 s57, 0, s57
    s_waitcnt vmcnt(3)
    buffer_load_dwordx4 v[88:91], v2, s[28:31], s56 offen nt
    s_waitcnt vmcnt(2)
    buffer_load_dwordx4 v[92:95], v2, s[28:31], s56 offen offset:1024 nt
    s_waitcnt vmcnt(2)
    buffer_load_dwordx4 v[96:99], v2, s[28:31], s56 offen offset:2048 nt
    s_waitcnt vmcnt(2)
    buffer_load_dwordx4 v[100:103], v2, s[28:31], s56 offen offset:3072 nt
    s_add_u32 s56, s56, 32768
    s_waitcnt vmcnt(2)
    buffer_load_dwordx4 v[104:107], v3, s[32:35], s57 offen
    s_add_u32 s57, s57, s58
    s_cmp_ge_u32 s57, s76
    s_cselect_b32 s57, 0, s57
    s_waitcnt vmcnt(2)
    buffer_load_dwordx4 v[108:111], v2, s[28:31], s56 offen nt
L_qjoin:
    s_waitcnt lgkmcnt(0)
    s_barrier
    v_lshlrev_b32 v46, 4, v39
    ds_read_b128 v[24:27], v46 offset:20480
    s_waitcnt lgkmcnt(0)
    v_mov_b32 v7, 0xff800000
    v_mov_b32 v33, 0
    s_mov_b32 s75, 0x3fb8aa3b
    s_lshl_b32 s73, s3, 11
    s_add_u32 s73, s73, 4096
    v_lshlrev_b32 v5, 2, v0
    v_add_u32 v5, s73, v5
    s_mul_i32 s73, s26, 0
    s_mov_b32 s95, 511
    v_and_b32 v6, 3, v39
    v_add_u32 v6, s73, v6
    v_and_b32 v6, 31, v6
    v_lshl_add_u32 v6, v6, 2, v38
    v_lshlrev_b32 v6, 2, v6
    v_mov_b32 v47, v6
    s_add_u32 s73, s72, 0
    v_mov_b32 v1, s73
    v_add_u32 v6, v1, v6
    ds_read_b32 v28, v6
    v_add_u32 v6, 64, v6
    v_and_or_b32 v6, v6, s95, v1
    s_waitcnt vmcnt(16)
    buffer_load_dwordx4 v[112:115], v2, s[28:31], s56 offen offset:1024 nt
    v_dot2_f32_bf16 v128, v48, v24, 0
    v_dot2_f32_bf16 v128, v49, v25, v128
    v_dot2_f32_bf16 v128, v50, v26, v128
    v_dot2_f32_bf16 v128, v51, v27, v128
    s_waitcnt vmcnt(16)
    buffer_load_dwordx4 v[116:119], v2, s[28:31], s56 offen offset:2048 nt
    v_dot2_f32_bf16 v129, v52, v24, 0
    v_dot2_f32_bf16 v129, v53, v25, v129
    v_dot2_f32_bf16 v129, v54, v26, v129
    v_dot2_f32_bf16 v129, v55, v27, v129
    s_waitcnt vmcnt(16)
    buffer_load_dwordx4 v[120:123], v2, s[28:31], s56 offen offset:3072 nt
    s_add_u32 s56, s56, 32768
    v_dot2_f32_bf16 v130, v56, v24, 0
    v_dot2_f32_bf16 v130, v57, v25, v130
    v_dot2_f32_bf16 v130, v58, v26, v130
    v_dot2_f32_bf16 v130, v59, v27, v130
    s_waitcnt vmcnt(16)
    v_dot2_f32_bf16 v131, v60, v24, 0
    v_dot2_f32_bf16 v131, v61, v25, v131
    v_dot2_f32_bf16 v131, v62, v26, v131
    v_dot2_f32_bf16 v131, v63, v27, v131
    s_waitcnt vmcnt(15)
    s_waitcnt lgkmcnt(0)
    v_lshlrev_b32 v29, 16, v28
    v_dot2c_f32_bf16_dpp v16, v28, v64 row_newbcast:0 row_mask:0xf bank_mask:0xf
    v_dot2c_f32_bf16_dpp v18, v28, v65 row_newbcast:0 row_mask:0xf bank_mask:0xf
    v_dot2c_f32_bf16_dpp v20, v28, v66 row_newbcast:0 row_mask:0xf bank_mask:0xf
    v_dot2c_f32_bf16_dpp v22, v28, v67 row_newbcast:0 row_mask:0xf bank_mask:0xf
    v_dot2c_f32_bf16_dpp v17, v29, v64 row_newbcast:0 row_mask:0xf bank_mask:0xf
    v_dot2c_f32_bf16_dpp v19, v29, v65 row_newbcast:0 row_mask:0xf bank_mask:0xf
    v_dot2c_f32_bf16_dpp v21, v29, v66 row_newbcast:0 row_mask:0xf bank_mask:0xf
    v_dot2c_f32_bf16_dpp v23, v29, v67 row_newbcast:0 row_mask:0xf bank_mask:0xf
    s_waitcnt vmcnt(14)
    v_dot2_f32_bf16 v132, v68, v24, 0
    v_dot2_f32_bf16 v132, v69, v25, v132
    v_dot2_f32_bf16 v132, v70, v26, v132
    v_dot2_f32_bf16 v132, v71, v27, v132
    s_waitcnt vmcnt(13)
    v_dot2_f32_bf16 v133, v72, v24, 0
    v_dot2_f32_bf16 v133, v73, v25, v133
    v_dot2_f32_bf16 v133, v74, v26, v133
    v_dot2_f32_bf16 v133, v75, v27, v133
    s_waitcnt vmcnt(12)
    v_dot2_f32_bf16 v134, v76, v24, 0
    v_dot2_f32_bf16 v134, v77, v25, v134
    v_dot2_f32_bf16 v134, v78, v26, v134
    v_dot2_f32_bf16 v134, v79, v27, v134
    s_waitcnt vmcnt(10)
    v_dot2_f32_bf16 v135, v80, v24, 0
    v_dot2_f32_bf16 v135, v81, v25, v135
    v_dot2_f32_bf16 v135, v82, v26, v135
    v_dot2_f32_bf16 v135, v83, v27, v135
    s_waitcnt vmcnt(9)
    v_dot2c_f32_bf16_dpp v16, v28, v84 row_newbcast:1 row_mask:0xf bank_mask:0xf
    v_dot2c_f32_bf16_dpp v18, v28, v85 row_newbcast:1 row_mask:0xf bank_mask:0xf
    v_dot2c_f32_bf16_dpp v20, v28, v86 row_newbcast:1 row_mask:0xf bank_mask:0xf
    v_dot2c_f32_bf16_dpp v22, v28, v87 row_newbcast:1 row_mask:0xf bank_mask:0xf
    v_dot2c_f32_bf16_dpp v17, v29, v84 row_newbcast:1 row_mask:0xf bank_mask:0xf
    v_dot2c_f32_bf16_dpp v19, v29, v85 row_newbcast:1 row_mask:0xf bank_mask:0xf
    v_dot2c_f32_bf16_dpp v21, v29, v86 row_newbcast:1 row_mask:0xf bank_mask:0xf
    v_dot2c_f32_bf16_dpp v23, v29, v87 row_newbcast:1 row_mask:0xf bank_mask:0xf
    s_waitcnt vmcnt(8)
    v_dot2_f32_bf16 v136, v88, v24, 0
    v_dot2_f32_bf16 v136, v89, v25, v136
    v_dot2_f32_bf16 v136, v90, v26, v136
    v_dot2_f32_bf16 v136, v91, v27, v136
    s_waitcnt vmcnt(7)
    v_dot2_f32_bf16 v137, v92, v24, 0
    v_dot2_f32_bf16 v137, v93, v25, v137
    v_dot2_f32_bf16 v137, v94, v26, v137
    v_dot2_f32_bf16 v137, v95, v27, v137
    s_waitcnt vmcnt(6)
    v_dot2_f32_bf16 v138, v96, v24, 0
    v_dot2_f32_bf16 v138, v97, v25, v138
    v_dot2_f32_bf16 v138, v98, v26, v138
    v_dot2_f32_bf16 v138, v99, v27, v138
    s_waitcnt vmcnt(5)
    v_dot2_f32_bf16 v139, v100, v24, 0
    v_dot2_f32_bf16 v139, v101, v25, v139
    v_dot2_f32_bf16 v139, v102, v26, v139
    v_dot2_f32_bf16 v139, v103, v27, v139
    s_waitcnt vmcnt(4)
    v_dot2c_f32_bf16_dpp v16, v28, v104 row_newbcast:2 row_mask:0xf bank_mask:0xf
    v_dot2c_f32_bf16_dpp v18, v28, v105 row_newbcast:2 row_mask:0xf bank_mask:0xf
    v_dot2c_f32_bf16_dpp v20, v28, v106 row_newbcast:2 row_mask:0xf bank_mask:0xf
    v_dot2c_f32_bf16_dpp v22, v28, v107 row_newbcast:2 row_mask:0xf bank_mask:0xf
    v_dot2c_f32_bf16_dpp v17, v29, v104 row_newbcast:2 row_mask:0xf bank_mask:0xf
    v_dot2c_f32_bf16_dpp v19, v29, v105 row_newbcast:2 row_mask:0xf bank_mask:0xf
    v_dot2c_f32_bf16_dpp v21, v29, v106 row_newbcast:2 row_mask:0xf bank_mask:0xf
    v_dot2c_f32_bf16_dpp v23, v29, v107 row_newbcast:2 row_mask:0xf bank_mask:0xf
    s_waitcnt vmcnt(3)
    buffer_load_dwordx4 v[124:127], v3, s[32:35], s57 offen
    s_add_u32 s57, s57, s58
    s_cmp_ge_u32 s57, s76
    s_cselect_b32 s57, 0, s57
    v_dot2_f32_bf16 v140, v108, v24, 0
    v_dot2_f32_bf16 v140, v109, v25, v140
    v_dot2_f32_bf16 v140, v110, v26, v140
    v_dot2_f32_bf16 v140, v111, v27, v140
    s_waitcnt vmcnt(3)
    buffer_load_dwordx4 v[48:51], v2, s[28:31], s56 offen nt
    v_dot2_f32_bf16 v141, v112, v24, 0
    v_dot2_f32_bf16 v141, v113, v25, v141
    v_dot2_f32_bf16 v141, v114, v26, v141
    v_dot2_f32_bf16 v141, v115, v27, v141
    s_waitcnt vmcnt(3)
    buffer_load_dwordx4 v[52:55], v2, s[28:31], s56 offen offset:1024 nt
    v_dot2_f32_bf16 v142, v116, v24, 0
    v_dot2_f32_bf16 v142, v117, v25, v142
    v_dot2_f32_bf16 v142, v118, v26, v142
    v_dot2_f32_bf16 v142, v119, v27, v142
    s_waitcnt vmcnt(3)
    buffer_load_dwordx4 v[56:59], v2, s[28:31], s56 offen offset:2048 nt
    v_dot2_f32_bf16 v143, v120, v24, 0
    v_dot2_f32_bf16 v143, v121, v25, v143
    v_dot2_f32_bf16 v143, v122, v26, v143
    v_dot2_f32_bf16 v143, v123, v27, v143
    s_waitcnt vmcnt(3)
    buffer_load_dwordx4 v[60:63], v2, s[28:31], s56 offen offset:3072 nt
    s_add_u32 s56, s56, 32768
    v_dot2c_f32_bf16_dpp v16, v28, v124 row_newbcast:3 row_mask:0xf bank_mask:0xf
    v_dot2c_f32_bf16_dpp v18, v28, v125 row_newbcast:3 row_mask:0xf bank_mask:0xf
    v_dot2c_f32_bf16_dpp v20, v28, v126 row_newbcast:3 row_mask:0xf bank_mask:0xf
    v_dot2c_f32_bf16_dpp v22, v28, v127 row_newbcast:3 row_mask:0xf bank_mask:0xf
    v_dot2c_f32_bf16_dpp v17, v29, v124 row_newbcast:3 row_mask:0xf bank_mask:0xf
    v_dot2c_f32_bf16_dpp v19, v29, v125 row_newbcast:3 row_mask:0xf bank_mask:0xf
    v_dot2c_f32_bf16_dpp v21, v29, v126 row_newbcast:3 row_mask:0xf bank_mask:0xf
    v_dot2c_f32_bf16_dpp v23, v29, v127 row_newbcast:3 row_mask:0xf bank_mask:0xf
    v_add_f32_dpp v128, v128, v128 row_ror:8 row_mask:0xf bank_mask:0x3
    v_add_f32_dpp v129, v129, v129 row_ror:8 row_mask:0xf bank_mask:0x3
    v_add_f32_dpp v130, v130, v130 row_ror:8 row_mask:0xf bank_mask:0x3
    v_add_f32_dpp v131, v131, v131 row_ror:8 row_mask:0xf bank_mask:0x3
    v_add_f32_dpp v132, v132, v132 row_ror:8 row_mask:0xf bank_mask:0x3
    v_add_f32_dpp v133, v133, v133 row_ror:8 row_mask:0xf bank_mask:0x3
    v_add_f32_dpp v134, v134, v134 row_ror:8 row_mask:0xf bank_mask:0x3
    v_add_f32_dpp v135, v135, v135 row_ror:8 row_mask:0xf bank_mask:0x3
    v_add_f32_dpp v128, v136, v136 row_ror:8 row_mask:0xf bank_mask:0xc
    v_add_f32_dpp v129, v137, v137 row_ror:8 row_mask:0xf bank_mask:0xc
    v_add_f32_dpp v130, v138, v138 row_ror:8 row_mask:0xf bank_mask:0xc
    v_add_f32_dpp v131, v139, v139 row_ror:8 row_mask:0xf bank_mask:0xc
    v_add_f32_dpp v132, v140, v140 row_ror:8 row_mask:0xf bank_mask:0xc
    v_add_f32_dpp v133, v141, v141 row_ror:8 row_mask:0xf bank_mask:0xc
    v_add_f32_dpp v134, v142, v142 row_ror:8 row_mask:0xf bank_mask:0xc
    v_add_f32_dpp v135, v143, v143 row_ror:8 row_mask:0xf bank_mask:0xc
    v_add_f32_dpp v128, v128, v128 row_shl:4 row_mask:0xf bank_mask:0x5
    v_add_f32_dpp v129, v129, v129 row_shl:4 row_mask:0xf bank_mask:0x5
    v_add_f32_dpp v130, v130, v130 row_shl:4 row_mask:0xf bank_mask:0x5
    v_add_f32_dpp v131, v131, v131 row_shl:4 row_mask:0xf bank_mask:0x5
    v_add_f32_dpp v128, v132, v132 row_shr:4 row_mask:0xf bank_mask:0xa
    v_add_f32_dpp v129, v133, v133 row_shr:4 row_mask:0xf bank_mask:0xa
    v_add_f32_dpp v130, v134, v134 row_shr:4 row_mask:0xf bank_mask:0xa
    v_add_f32_dpp v131, v135, v135 row_shr:4 row_mask:0xf bank_mask:0xa
    v_cndmask_b32 v132, v128, v130, s[62:63]
    v_cndmask_b32 v134, v130, v128, s[62:63]
    v_cndmask_b32 v133, v129, v131, s[62:63]
    v_cndmask_b32 v135, v131, v129, s[62:63]
    s_nop 0
    v_add_f32_dpp v128, v134, v132 quad_perm:[2,3,0,1] row_mask:0xf bank_mask:0xf
    v_add_f32_dpp v129, v135, v133 quad_perm:[2,3,0,1] row_mask:0xf bank_mask:0xf
    v_cndmask_b32 v132, v128, v129, s[64:65]
    v_cndmask_b32 v134, v129, v128, s[64:65]
    s_nop 1
    v_add_f32_dpp v128, v134, v132 quad_perm:[1,0,3,2] row_mask:0xf bank_mask:0xf
    v_cvt_pk_bf16_f32 v128, v128, v128
    v_lshlrev_b32 v128, 16, v128
    v_mul_f32 v128, 0x3db504f3, v128
    v_cvt_pk_bf16_f32 v128, v128, v128
    v_lshlrev_b32 v128, 16, v128
    ds_write_b32 v5, v128
    v_max_f32 v129, v7, v128
    v_sub_f32 v130, v7, v129
    v_sub_f32 v131, v128, v129
    v_mul_f32 v130, s75, v130
    v_mul_f32 v131, s75, v131
    v_exp_f32 v130, v130
    v_exp_f32 v131, v131
    v_mov_b32 v7, v129
    v_fma_f32 v33, v33, v130, v131
    v_add_u32 v5, 256, v5
    s_barrier
    s_mov_b32 s59, 1
L_kloop:
    ds_read_b32 v28, v6
    v_add_u32 v6, 64, v6
    v_and_or_b32 v6, v6, s95, v1
    s_or_b32 s73, s3, s27
    s_cmp_lg_u32 s73, 0
    s_cbranch_scc1 L_nozero
    s_cmp_lg_u32 s59, 1
    s_cbranch_scc1 L_nozero
    v_mov_b32 v12, 0
    v_mov_b32 v13, 0
    v_mov_b32 v14, 0
    v_mov_b32 v15, 0
    s_lshl_b32 s73, s26, 12
    buffer_store_dwordx4 v[12:15], v2, s[48:51], s73 offen offset:0 sc1
    buffer_store_dwordx4 v[12:15], v2, s[48:51], s73 offen offset:1024 sc1
    buffer_store_dwordx4 v[12:15], v2, s[48:51], s73 offen offset:2048 sc1
    buffer_store_dwordx4 v[12:15], v2, s[48:51], s73 offen offset:3072 sc1
    s_add_u32 s73, s73, 32768
    buffer_store_dwordx4 v[12:15], v2, s[48:51], s73 offen offset:0 sc1
    buffer_store_dwordx4 v[12:15], v2, s[48:51], s73 offen offset:1024 sc1
    buffer_store_dwordx4 v[12:15], v2, s[48:51], s73 offen offset:2048 sc1
    buffer_store_dwordx4 v[12:15], v2, s[48:51], s73 offen offset:3072 sc1
    s_lshl_b32 s73, s26, 10
    s_add_u32 s73, s73, 65536
    buffer_store_dwordx4 v[12:15], v2, s[48:51], s73 offen sc1
    s_waitcnt vmcnt(0)
    v_mov_b32 v46, 4
    v_mov_b32 v40, 1
    s_mov_b64 exec, 1
    buffer_store_dword v40, v46, s[44:47], s70 offen sc1
    s_mov_b64 exec, -1
L_nozero:
    s_waitcnt vmcnt(3)
    v_dot2_f32_bf16 v128, v48, v24, 0
    v_dot2_f32_bf16 v128, v49, v25, v128
    v_dot2_f32_bf16 v128, v50, v26, v128
    v_dot2_f32_bf16 v128, v51, v27, v128
    s_waitcnt vmcnt(2)
    buffer_load_dwordx4 v[64:67], v3, s[32:35], s57 offen
    s_add_u32 s57, s57, s58
    s_cmp_ge_u32 s57, s76
    s_cselect_b32 s57, 0, s57
    v_dot2_f32_bf16 v129, v52, v24, 0
    v_dot2_f32_bf16 v129, v53, v25, v129
    v_dot2_f32_bf16 v129, v54, v26, v129
    v_dot2_f32_bf16 v129, v55, v27, v129
    s_waitcnt vmcnt(2)
    buffer_load_dwordx4 v[68:71], v2, s[28:31], s56 offen nt
    buffer_load_dwordx4 v[72:75], v2, s[28:31], s56 offen offset:1024 nt
    v_dot2_f32_bf16 v130, v56, v24, 0
    v_dot2_f32_bf16 v130, v57, v25, v130
    v_dot2_f32_bf16 v130, v58, v26, v130
    v_dot2_f32_bf16 v130, v59, v27, v130
    s_waitcnt vmcnt(3)
    buffer_load_dwordx4 v[76:79], v2, s[28:31], s56 offen offset:2048 nt
    v_dot2_f32_bf16 v131, v60, v24, 0
    v_dot2_f32_bf16 v131, v61, v25, v131
    v_dot2_f32_bf16 v131, v62, v26, v131
    v_dot2_f32_bf16 v131, v63, v27, v131
    s_waitcnt vmcnt(3)
    s_waitcnt lgkmcnt(0)
    v_lshlrev_b32 v29, 16, v28
    v_dot2c_f32_bf16_dpp v16, v28, v64 row_newbcast:0 row_mask:0xf bank_mask:0xf
    v_dot2c_f32_bf16_dpp v18, v28, v65 row_newbcast:0 row_mask:0xf bank_mask:0xf
    v_dot2c_f32_bf16_dpp v20, v28, v66 row_newbcast:0 row_mask:0xf bank_mask:0xf
    v_dot2c_f32_bf16_dpp v22, v28, v67 row_newbcast:0 row_mask:0xf bank_mask:0xf
    v_dot2c_f32_bf16_dpp v17, v29, v64 row_newbcast:0 row_mask:0xf bank_mask:0xf
    v_dot2c_f32_bf16_dpp v19, v29, v65 row_newbcast:0 row_mask:0xf bank_mask:0xf
    v_dot2c_f32_bf16_dpp v21, v29, v66 row_newbcast:0 row_mask:0xf bank_mask:0xf
    v_dot2c_f32_bf16_dpp v23, v29, v67 row_newbcast:0 row_mask:0xf bank_mask:0xf
    s_waitcnt vmcnt(2)
    buffer_load_dwordx4 v[80:83], v2, s[28:31], s56 offen offset:3072 nt
    s_add_u32 s56, s56, 32768
    v_dot2_f32_bf16 v132, v68, v24, 0
    v_dot2_f32_bf16 v132, v69, v25, v132
    v_dot2_f32_bf16 v132, v70, v26, v132
    v_dot2_f32_bf16 v132, v71, v27, v132
    s_waitcnt vmcnt(2)
    buffer_load_dwordx4 v[84:87], v3, s[32:35], s57 offen
    s_add_u32 s57, s57, s58
    s_cmp_ge_u32 s57, s76
    s_cselect_b32 s57, 0, s57
    v_dot2_f32_bf16 v133, v72, v24, 0
    v_dot2_f32_bf16 v133, v73, v25, v133
    v_dot2_f32_bf16 v133, v74, v26, v133
    v_dot2_f32_bf16 v133, v75, v27, v133
    s_waitcnt vmcnt(2)
    buffer_load_dwordx4 v[88:91], v2, s[28:31], s56 offen nt
    buffer_load_dwordx4 v[92:95], v2, s[28:31], s56 offen offset:1024 nt
    v_dot2_f32_bf16 v134, v76, v24, 0
    v_dot2_f32_bf16 v134, v77, v25, v134
    v_dot2_f32_bf16 v134, v78, v26, v134
    v_dot2_f32_bf16 v134, v79, v27, v134
    s_waitcnt vmcnt(3)
    buffer_load_dwordx4 v[96:99], v2, s[28:31], s56 offen offset:2048 nt
    v_dot2_f32_bf16 v135, v80, v24, 0
    v_dot2_f32_bf16 v135, v81, v25, v135
    v_dot2_f32_bf16 v135, v82, v26, v135
    v_dot2_f32_bf16 v135, v83, v27, v135
    s_waitcnt vmcnt(3)
    v_dot2c_f32_bf16_dpp v16, v28, v84 row_newbcast:1 row_mask:0xf bank_mask:0xf
    v_dot2c_f32_bf16_dpp v18, v28, v85 row_newbcast:1 row_mask:0xf bank_mask:0xf
    v_dot2c_f32_bf16_dpp v20, v28, v86 row_newbcast:1 row_mask:0xf bank_mask:0xf
    v_dot2c_f32_bf16_dpp v22, v28, v87 row_newbcast:1 row_mask:0xf bank_mask:0xf
    v_dot2c_f32_bf16_dpp v17, v29, v84 row_newbcast:1 row_mask:0xf bank_mask:0xf
    v_dot2c_f32_bf16_dpp v19, v29, v85 row_newbcast:1 row_mask:0xf bank_mask:0xf
    v_dot2c_f32_bf16_dpp v21, v29, v86 row_newbcast:1 row_mask:0xf bank_mask:0xf
    v_dot2c_f32_bf16_dpp v23, v29, v87 row_newbcast:1 row_mask:0xf bank_mask:0xf
    s_waitcnt vmcnt(2)
    buffer_load_dwordx4 v[100:103], v2, s[28:31], s56 offen offset:3072 nt
    s_add_u32 s56, s56, 32768
    v_dot2_f32_bf16 v136, v88, v24, 0
    v_dot2_f32_bf16 v136, v89, v25, v136
    v_dot2_f32_bf16 v136, v90, v26, v136
    v_dot2_f32_bf16 v136, v91, v27, v136
    s_waitcnt vmcnt(2)
    buffer_load_dwordx4 v[104:107], v3, s[32:35], s57 offen
    s_add_u32 s57, s57, s58
    s_cmp_ge_u32 s57, s76
    s_cselect_b32 s57, 0, s57
    v_dot2_f32_bf16 v137, v92, v24, 0
    v_dot2_f32_bf16 v137, v93, v25, v137
    v_dot2_f32_bf16 v137, v94, v26, v137
    v_dot2_f32_bf16 v137, v95, v27, v137
    s_waitcnt vmcnt(2)
    buffer_load_dwordx4 v[108:111], v2, s[28:31], s56 offen nt
    buffer_load_dwordx4 v[112:115], v2, s[28:31], s56 offen offset:1024 nt
    v_dot2_f32_bf16 v138, v96, v24, 0
    v_dot2_f32_bf16 v138, v97, v25, v138
    v_dot2_f32_bf16 v138, v98, v26, v138
    v_dot2_f32_bf16 v138, v99, v27, v138
    s_waitcnt vmcnt(3)
    buffer_load_dwordx4 v[116:119], v2, s[28:31], s56 offen offset:2048 nt
    v_dot2_f32_bf16 v139, v100, v24, 0
    v_dot2_f32_bf16 v139, v101, v25, v139
    v_dot2_f32_bf16 v139, v102, v26, v139
    v_dot2_f32_bf16 v139, v103, v27, v139
    s_waitcnt vmcnt(3)
    v_dot2c_f32_bf16_dpp v16, v28, v104 row_newbcast:2 row_mask:0xf bank_mask:0xf
    v_dot2c_f32_bf16_dpp v18, v28, v105 row_newbcast:2 row_mask:0xf bank_mask:0xf
    v_dot2c_f32_bf16_dpp v20, v28, v106 row_newbcast:2 row_mask:0xf bank_mask:0xf
    v_dot2c_f32_bf16_dpp v22, v28, v107 row_newbcast:2 row_mask:0xf bank_mask:0xf
    v_dot2c_f32_bf16_dpp v17, v29, v104 row_newbcast:2 row_mask:0xf bank_mask:0xf
    v_dot2c_f32_bf16_dpp v19, v29, v105 row_newbcast:2 row_mask:0xf bank_mask:0xf
    v_dot2c_f32_bf16_dpp v21, v29, v106 row_newbcast:2 row_mask:0xf bank_mask:0xf
    v_dot2c_f32_bf16_dpp v23, v29, v107 row_newbcast:2 row_mask:0xf bank_mask:0xf
    s_waitcnt vmcnt(2)
    buffer_load_dwordx4 v[120:123], v2, s[28:31], s56 offen offset:3072 nt
    s_add_u32 s56, s56, 32768
    v_dot2_f32_bf16 v140, v108, v24, 0
    v_dot2_f32_bf16 v140, v109, v25, v140
    v_dot2_f32_bf16 v140, v110, v26, v140
    v_dot2_f32_bf16 v140, v111, v27, v140
    s_waitcnt vmcnt(2)
    buffer_load_dwordx4 v[124:127], v3, s[32:35], s57 offen
    s_add_u32 s57, s57, s58
    s_cmp_ge_u32 s57, s76
    s_cselect_b32 s57, 0, s57
    v_dot2_f32_bf16 v141, v112, v24, 0
    v_dot2_f32_bf16 v141, v113, v25, v141
    v_dot2_f32_bf16 v141, v114, v26, v141
    v_dot2_f32_bf16 v141, v115, v27, v141
    s_waitcnt vmcnt(2)
    s_cmp_eq_u32 s59, 7
    s_cbranch_scc0 L_nosw
    s_add_u32 s28, s8, s68
    s_addc_u32 s29, s9, 0
    s_lshl_b32 s56, s3, 12
    s_lshl_b32 s73, s71, 18
    s_add_u32 s32, s18, s73
    s_addc_u32 s33, s19, 0
    s_mov_b32 s34, 262144
    s_mul_i32 s57, s26, 0
    s_mov_b32 s58, 8192
    s_mov_b32 s76, 262144
    v_mov_b32 v3, v4
L_nosw:
    buffer_load_dwordx4 v[48:51], v2, s[28:31], s56 offen nt
    buffer_load_dwordx4 v[52:55], v2, s[28:31], s56 offen offset:1024 nt
    v_dot2_f32_bf16 v142, v116, v24, 0
    v_dot2_f32_bf16 v142, v117, v25, v142
    v_dot2_f32_bf16 v142, v118, v26, v142
    v_dot2_f32_bf16 v142, v119, v27, v142
    s_waitcnt vmcnt(3)
    buffer_load_dwordx4 v[56:59], v2, s[28:31], s56 offen offset:2048 nt
    v_dot2_f32_bf16 v143, v120, v24, 0
    v_dot2_f32_bf16 v143, v121, v25, v143
    v_dot2_f32_bf16 v143, v122, v26, v143
    v_dot2_f32_bf16 v143, v123, v27, v143
    s_waitcnt vmcnt(3)
    buffer_load_dwordx4 v[60:63], v2, s[28:31], s56 offen offset:3072 nt
    s_add_u32 s56, s56, 32768
    v_dot2c_f32_bf16_dpp v16, v28, v124 row_newbcast:3 row_mask:0xf bank_mask:0xf
    v_dot2c_f32_bf16_dpp v18, v28, v125 row_newbcast:3 row_mask:0xf bank_mask:0xf
    v_dot2c_f32_bf16_dpp v20, v28, v126 row_newbcast:3 row_mask:0xf bank_mask:0xf
    v_dot2c_f32_bf16_dpp v22, v28, v127 row_newbcast:3 row_mask:0xf bank_mask:0xf
    v_dot2c_f32_bf16_dpp v17, v29, v124 row_newbcast:3 row_mask:0xf bank_mask:0xf
    v_dot2c_f32_bf16_dpp v19, v29, v125 row_newbcast:3 row_mask:0xf bank_mask:0xf
    v_dot2c_f32_bf16_dpp v21, v29, v126 row_newbcast:3 row_mask:0xf bank_mask:0xf
    v_dot2c_f32_bf16_dpp v23, v29, v127 row_newbcast:3 row_mask:0xf bank_mask:0xf
    v_add_f32_dpp v128, v128, v128 row_ror:8 row_mask:0xf bank_mask:0x3
    v_add_f32_dpp v129, v129, v129 row_ror:8 row_mask:0xf bank_mask:0x3
    v_add_f32_dpp v130, v130, v130 row_ror:8 row_mask:0xf bank_mask:0x3
    v_add_f32_dpp v131, v131, v131 row_ror:8 row_mask:0xf bank_mask:0x3
    v_add_f32_dpp v132, v132, v132 row_ror:8 row_mask:0xf bank_mask:0x3
    v_add_f32_dpp v133, v133, v133 row_ror:8 row_mask:0xf bank_mask:0x3
    v_add_f32_dpp v134, v134, v134 row_ror:8 row_mask:0xf bank_mask:0x3
    v_add_f32_dpp v135, v135, v135 row_ror:8 row_mask:0xf bank_mask:0x3
    v_add_f32_dpp v128, v136, v136 row_ror:8 row_mask:0xf bank_mask:0xc
    v_add_f32_dpp v129, v137, v137 row_ror:8 row_mask:0xf bank_mask:0xc
    v_add_f32_dpp v130, v138, v138 row_ror:8 row_mask:0xf bank_mask:0xc
    v_add_f32_dpp v131, v139, v139 row_ror:8 row_mask:0xf bank_mask:0xc
    v_add_f32_dpp v132, v140, v140 row_ror:8 row_mask:0xf bank_mask:0xc
    v_add_f32_dpp v133, v141, v141 row_ror:8 row_mask:0xf bank_mask:0xc
    v_add_f32_dpp v134, v142, v142 row_ror:8 row_mask:0xf bank_mask:0xc
    v_add_f32_dpp v135, v143, v143 row_ror:8 row_mask:0xf bank_mask:0xc
    v_add_f32_dpp v128, v128, v128 row_shl:4 row_mask:0xf bank_mask:0x5
    v_add_f32_dpp v129, v129, v129 row_shl:4 row_mask:0xf bank_mask:0x5
    v_add_f32_dpp v130, v130, v130 row_shl:4 row_mask:0xf bank_mask:0x5
    v_add_f32_dpp v131, v131, v131 row_shl:4 row_mask:0xf bank_mask:0x5
    v_add_f32_dpp v128, v132, v132 row_shr:4 row_mask:0xf bank_mask:0xa
    v_add_f32_dpp v129, v133, v133 row_shr:4 row_mask:0xf bank_mask:0xa
    v_add_f32_dpp v130, v134, v134 row_shr:4 row_mask:0xf bank_mask:0xa
    v_add_f32_dpp v131, v135, v135 row_shr:4 row_mask:0xf bank_mask:0xa
    v_cndmask_b32 v132, v128, v130, s[62:63]
    v_cndmask_b32 v134, v130, v128, s[62:63]
    v_cndmask_b32 v133, v129, v131, s[62:63]
    v_cndmask_b32 v135, v131, v129, s[62:63]
    s_nop 0
    v_add_f32_dpp v128, v134, v132 quad_perm:[2,3,0,1] row_mask:0xf bank_mask:0xf
    v_add_f32_dpp v129, v135, v133 quad_perm:[2,3,0,1] row_mask:0xf bank_mask:0xf
    v_cndmask_b32 v132, v128, v129, s[64:65]
    v_cndmask_b32 v134, v129, v128, s[64:65]
    s_nop 1
    v_add_f32_dpp v128, v134, v132 quad_perm:[1,0,3,2] row_mask:0xf bank_mask:0xf
    v_cvt_pk_bf16_f32 v128, v128, v128
    v_lshlrev_b32 v128, 16, v128
    v_mul_f32 v128, 0x3db504f3, v128
    v_cvt_pk_bf16_f32 v128, v128, v128
    v_lshlrev_b32 v128, 16, v128
    ds_write_b32 v5, v128
    v_max_f32 v129, v7, v128
    v_sub_f32 v130, v7, v129
    v_sub_f32 v131, v128, v129
    v_mul_f32 v130, s75, v130
    v_mul_f32 v131, s75, v131
    v_exp_f32 v130, v130
    v_exp_f32 v131, v131
    v_mov_b32 v7, v129
    v_fma_f32 v33, v33, v130, v131
    v_add_u32 v5, 256, v5
    s_barrier
    s_add_u32 s59, s59, 1
    s_cmp_lt_u32 s59, 8
    s_cbranch_scc1 L_kloop
    buffer_load_dwordx4 v[64:67], v3, s[32:35], s57 offen
    s_add_u32 s57, s57, s58
    s_cmp_ge_u32 s57, s76
    s_cselect_b32 s57, 0, s57
    buffer_load_dwordx4 v[68:71], v2, s[28:31], s56 offen nt
    s_cmp_lg_u32 s3, 0
    s_cbranch_scc1 L_nopoll
    v_mov_b32 v46, 4
    buffer_load_dword v32, v46, s[44:47], s70 offen sc1
L_nopoll:
    v_subrev_u32 v5, 2048, v5
    s_waitcnt lgkmcnt(0)
    ds_read_b32 v208, v5 offset:0
    ds_read_b32 v209, v5 offset:256
    ds_read_b32 v210, v5 offset:512
    ds_read_b32 v211, v5 offset:768
    ds_read_b32 v212, v5 offset:1024
    ds_read_b32 v213, v5 offset:1280
    ds_read_b32 v214, v5 offset:1536
    ds_read_b32 v215, v5 offset:1792
    v_mov_b32 v40, v7
    s_nop 1
    v_max_f32_dpp v40, v40, v40 row_ror:8 row_mask:0xf bank_mask:0xf
    v_permlane32_swap_b32 v16, v20
    v_permlane32_swap_b32 v17, v21
    v_max_f32_dpp v40, v40, v40 row_ror:4 row_mask:0xf bank_mask:0xf
    v_permlane32_swap_b32 v18, v22
    v_permlane32_swap_b32 v19, v23
    v_max_f32_dpp v40, v40, v40 row_ror:2 row_mask:0xf bank_mask:0xf
    v_add_f32 v16, v16, v20
    v_add_f32 v17, v17, v21
    v_max_f32_dpp v40, v40, v40 row_ror:1 row_mask:0xf bank_mask:0xf
    v_add_f32 v18, v18, v22
    v_add_f32 v19, v19, v23
    v_mov_b32 v41, v40
    v_permlane16_swap_b32 v16, v18
    v_permlane16_swap_b32 v17, v19
    v_permlane16_swap_b32 v40, v41
    v_max_f32 v40, v40, v41
    v_mov_b32 v41, v40
    v_add_f32 v16, v16, v18
    v_add_f32 v17, v17, v19
    v_permlane32_swap_b32 v40, v41
    v_max_f32 v40, v40, v41
    ds_write_b64 v45, v[16:17] offset:24576
    v_sub_f32 v42, v7, v40
    v_mul_f32 v42, s75, v42
    v_exp_f32 v42, v42
    s_nop 0
    v_mul_f32 v41, v33, v42
    s_nop 1
    v_add_f32_dpp v41, v41, v41 row_ror:8 row_mask:0xf bank_mask:0xf
    s_nop 1
    v_add_f32_dpp v41, v41, v41 row_ror:4 row_mask:0xf bank_mask:0xf
    s_nop 1
    v_add_f32_dpp v41, v41, v41 row_ror:2 row_mask:0xf bank_mask:0xf
    s_nop 1
    v_add_f32_dpp v41, v41, v41 row_ror:1 row_mask:0xf bank_mask:0xf
    v_mov_b32 v42, v41
    s_nop 1
    v_permlane16_swap_b32 v41, v42
    v_add_f32 v41, v41, v42
    v_mov_b32 v42, v41
    s_nop 1
    v_permlane32_swap_b32 v41, v42
    v_add_f32 v41, v41, v42
    s_lshl_b32 s74, s3, 3
    v_mov_b32 v42, s74
    ds_write_b64 v42, v[40:41] offset:36864
    v_lshl_add_u32 v43, v39, 2, v38
    v_lshlrev_b32 v43, 2, v43
    v_add_u32 v29, 24576, v43
    v_mov_b32 v42, 0
    s_add_u32 s74, s72, 32768
    v_add_u32 v43, s74, v43
    v_mov_b32 v1, s74
    v_add_u32 v6, s74, v47
    v_mov_b32 v8, 0
    v_mov_b32 v9, 0
    v_mov_b32 v10, 0
    v_mov_b32 v11, 0
    v_mov_b32 v12, 0
    v_mov_b32 v13, 0
    v_mov_b32 v14, 0
    v_mov_b32 v15, 0
    v_mov_b32 v16, 0
    v_mov_b32 v17, 0
    v_mov_b32 v18, 0
    v_mov_b32 v19, 0
    v_mov_b32 v20, 0
    v_mov_b32 v21, 0
    v_mov_b32 v22, 0
    v_mov_b32 v23, 0
    s_lshl_b32 s73, s27, 18
    s_add_u32 s36, s12, s73
    s_addc_u32 s37, s13, 0
    s_mov_b32 s38, 262144
    s_mul_i32 s60, s26, 32768
    s_and_b32 s60, s60, 0x3ffff
    s_waitcnt lgkmcnt(0)
    s_barrier
    ds_read_b128 v[224:227], v42 offset:36864
    ds_read_b128 v[228:231], v42 offset:36880
    ds_read_b128 v[232:235], v42 offset:36896
    ds_read_b128 v[236:239], v42 offset:36912
    ds_read2st64_b32 v[240:241], v29 offset0:0 offset1:1
    ds_read2st64_b32 v[242:243], v29 offset0:2 offset1:3
    ds_read2st64_b32 v[244:245], v29 offset0:4 offset1:5
    ds_read2st64_b32 v[246:247], v29 offset0:6 offset1:7
    ds_read2st64_b32 v[248:249], v29 offset0:8 offset1:9
    ds_read2st64_b32 v[250:251], v29 offset0:10 offset1:11
    ds_read2st64_b32 v[252:253], v29 offset0:12 offset1:13
    ds_read2st64_b32 v[254:255], v29 offset0:14 offset1:15
    s_waitcnt lgkmcnt(8)
    v_max3_f32 v40, v224, v226, v228
    v_max3_f32 v42, v230, v232, v234
    v_max3_f32 v40, v40, v236, v238
    v_max_f32 v40, v40, v42
    v_sub_f32 v224, v224, v40
    v_sub_f32 v226, v226, v40
    v_sub_f32 v228, v228, v40
    v_sub_f32 v230, v230, v40
    v_sub_f32 v232, v232, v40
    v_sub_f32 v234, v234, v40
    v_sub_f32 v236, v236, v40
    v_sub_f32 v238, v238, v40
    v_sub_f32 v216, v208, v40
    v_mul_f32 v224, s75, v224
    v_mul_f32 v226, s75, v226
    v_mul_f32 v228, s75, v228
    v_mul_f32 v230, s75, v230
    v_mul_f32 v232, s75, v232
    v_mul_f32 v234, s75, v234
    v_mul_f32 v236, s75, v236
    v_mul_f32 v238, s75, v238
    v_mul_f32 v216, s75, v216
    v_exp_f32 v224, v224
    v_exp_f32 v226, v226
    v_exp_f32 v228, v228
    v_exp_f32 v230, v230
    v_exp_f32 v232, v232
    v_exp_f32 v234, v234
    v_exp_f32 v236, v236
    v_exp_f32 v238, v238
    v_exp_f32 v216, v216
    v_mul_f32 v41, v224, v225
    v_mul_f32 v42, v226, v227
    v_fmac_f32 v41, v228, v229
    v_fmac_f32 v42, v230, v231
    v_fmac_f32 v41, v232, v233
    v_fmac_f32 v42, v234, v235
    v_fmac_f32 v41, v236, v237
    v_fmac_f32 v42, v238, v239
    v_add_f32 v41, v41, v42
    v_rcp_f32 v46, v41
    s_nop 0
    v_mul_f32 v30, v216, v46
    v_fma_f32 v216, -v30, v41, v216
    v_fma_f32 v30, v216, v46, v30
    v_cvt_pk_bf16_f32 v30, v30, 0
    v_lshlrev_b32 v31, 16, v30
    s_nop 1
    s_waitcnt vmcnt(5)
    buffer_load_dwordx4 v[72:75], v2, s[28:31], s56 offen offset:1024 nt
    v_dot2c_f32_bf16_dpp v8, v30, v48 row_newbcast:0 row_mask:0xf bank_mask:0xf
    v_dot2c_f32_bf16_dpp v10, v30, v49 row_newbcast:0 row_mask:0xf bank_mask:0xf
    v_dot2c_f32_bf16_dpp v12, v30, v50 row_newbcast:0 row_mask:0xf bank_mask:0xf
    v_dot2c_f32_bf16_dpp v14, v30, v51 row_newbcast:0 row_mask:0xf bank_mask:0xf
    v_dot2c_f32_bf16_dpp v9, v31, v48 row_newbcast:0 row_mask:0xf bank_mask:0xf
    v_dot2c_f32_bf16_dpp v11, v31, v49 row_newbcast:0 row_mask:0xf bank_mask:0xf
    v_dot2c_f32_bf16_dpp v13, v31, v50 row_newbcast:0 row_mask:0xf bank_mask:0xf
    v_dot2c_f32_bf16_dpp v15, v31, v51 row_newbcast:0 row_mask:0xf bank_mask:0xf
    s_waitcnt lgkmcnt(0)
    v_add_f32 v240, v240, v248
    v_add_f32 v241, v241, v249
    v_add_f32 v242, v242, v250
    v_add_f32 v243, v243, v251
    v_add_f32 v244, v244, v252
    v_add_f32 v245, v245, v253
    v_add_f32 v246, v246, v254
    v_add_f32 v247, v247, v255
    v_add_f32 v240, v240, v244
    v_add_f32 v241, v241, v245
    v_add_f32 v242, v242, v246
    v_add_f32 v243, v243, v247
    v_add_f32 v240, v240, v242
    v_add_f32 v241, v241, v243
    v_max_f32 v240, 0, v240
    v_max_f32 v241, 0, v241
    v_cvt_pk_bf16_f32 v240, v240, 0
    v_cvt_pk_bf16_f32 v241, v241, 0
    ds_write_b32 v43, v240
    ds_write_b32 v43, v241 offset:256
    ds_read_b32 v28, v6
    v_add_u32 v6, 64, v6
    v_and_or_b32 v6, v6, s95, v1
    s_waitcnt vmcnt(5)
    buffer_load_dwordx4 v[76:79], v2, s[28:31], s56 offen offset:2048 nt
    v_dot2c_f32_bf16_dpp v8, v30, v52 row_newbcast:1 row_mask:0xf bank_mask:0xf
    v_dot2c_f32_bf16_dpp v10, v30, v53 row_newbcast:1 row_mask:0xf bank_mask:0xf
    v_dot2c_f32_bf16_dpp v12, v30, v54 row_newbcast:1 row_mask:0xf bank_mask:0xf
    v_dot2c_f32_bf16_dpp v14, v30, v55 row_newbcast:1 row_mask:0xf bank_mask:0xf
    v_dot2c_f32_bf16_dpp v9, v31, v52 row_newbcast:1 row_mask:0xf bank_mask:0xf
    v_dot2c_f32_bf16_dpp v11, v31, v53 row_newbcast:1 row_mask:0xf bank_mask:0xf
    v_dot2c_f32_bf16_dpp v13, v31, v54 row_newbcast:1 row_mask:0xf bank_mask:0xf
    v_dot2c_f32_bf16_dpp v15, v31, v55 row_newbcast:1 row_mask:0xf bank_mask:0xf
    v_sub_f32 v217, v209, v40
    v_mul_f32 v217, s75, v217
    v_sub_f32 v218, v210, v40
    v_mul_f32 v218, s75, v218
    v_exp_f32 v217, v217
    v_exp_f32 v218, v218
    s_nop 0
    v_mul_f32 v209, v217, v46
    v_fma_f32 v217, -v209, v41, v217
    v_fma_f32 v209, v217, v46, v209
    v_cvt_pk_bf16_f32 v209, v209, 0
    ds_write_b32 v5, v209 offset:256
    v_mul_f32 v210, v218, v46
    v_fma_f32 v218, -v210, v41, v218
    v_fma_f32 v210, v218, v46, v210
    v_cvt_pk_bf16_f32 v210, v210, 0
    ds_write_b32 v5, v210 offset:512
    s_waitcnt vmcnt(5)
    buffer_load_dwordx4 v[80:83], v2, s[28:31], s56 offen offset:3072 nt
    s_add_u32 s56, s56, 32768
    v_dot2c_f32_bf16_dpp v8, v30, v56 row_newbcast:2 row_mask:0xf bank_mask:0xf
    v_dot2c_f32_bf16_dpp v10, v30, v57 row_newbcast:2 row_mask:0xf bank_mask:0xf
    v_dot2c_f32_bf16_dpp v12, v30, v58 row_newbcast:2 row_mask:0xf bank_mask:0xf
    v_dot2c_f32_bf16_dpp v14, v30, v59 row_newbcast:2 row_mask:0xf bank_mask:0xf
    v_dot2c_f32_bf16_dpp v9, v31, v56 row_newbcast:2 row_mask:0xf bank_mask:0xf
    v_dot2c_f32_bf16_dpp v11, v31, v57 row_newbcast:2 row_mask:0xf bank_mask:0xf
    v_dot2c_f32_bf16_dpp v13, v31, v58 row_newbcast:2 row_mask:0xf bank_mask:0xf
    v_dot2c_f32_bf16_dpp v15, v31, v59 row_newbcast:2 row_mask:0xf bank_mask:0xf
    v_sub_f32 v219, v211, v40
    v_mul_f32 v219, s75, v219
    v_sub_f32 v220, v212, v40
    v_mul_f32 v220, s75, v220
    v_exp_f32 v219, v219
    v_exp_f32 v220, v220
    s_nop 0
    v_mul_f32 v211, v219, v46
    v_fma_f32 v219, -v211, v41, v219
    v_fma_f32 v211, v219, v46, v211
    v_cvt_pk_bf16_f32 v211, v211, 0
    ds_write_b32 v5, v211 offset:768
    v_mul_f32 v212, v220, v46
    v_fma_f32 v220, -v212, v41, v220
    v_fma_f32 v212, v220, v46, v212
    v_cvt_pk_bf16_f32 v212, v212, 0
    ds_write_b32 v5, v212 offset:1024
    s_waitcnt vmcnt(5)
    buffer_load_dwordx4 v[84:87], v3, s[32:35], s57 offen
    s_add_u32 s57, s57, s58
    s_cmp_ge_u32 s57, s76
    s_cselect_b32 s57, 0, s57
    v_dot2c_f32_bf16_dpp v8, v30, v60 row_newbcast:3 row_mask:0xf bank_mask:0xf
    v_dot2c_f32_bf16_dpp v10, v30, v61 row_newbcast:3 row_mask:0xf bank_mask:0xf
    v_dot2c_f32_bf16_dpp v12, v30, v62 row_newbcast:3 row_mask:0xf bank_mask:0xf
    v_dot2c_f32_bf16_dpp v14, v30, v63 row_newbcast:3 row_mask:0xf bank_mask:0xf
    v_dot2c_f32_bf16_dpp v9, v31, v60 row_newbcast:3 row_mask:0xf bank_mask:0xf
    v_dot2c_f32_bf16_dpp v11, v31, v61 row_newbcast:3 row_mask:0xf bank_mask:0xf
    v_dot2c_f32_bf16_dpp v13, v31, v62 row_newbcast:3 row_mask:0xf bank_mask:0xf
    v_dot2c_f32_bf16_dpp v15, v31, v63 row_newbcast:3 row_mask:0xf bank_mask:0xf
    v_sub_f32 v221, v213, v40
    v_mul_f32 v221, s75, v221
    v_exp_f32 v221, v221
    s_nop 0
    v_mul_f32 v213, v221, v46
    v_fma_f32 v221, -v213, v41, v221
    v_fma_f32 v213, v221, v46, v213
    v_cvt_pk_bf16_f32 v213, v213, 0
    ds_write_b32 v5, v213 offset:1280
    s_waitcnt lgkmcnt(0)
    v_lshlrev_b32 v29, 16, v28
    s_nop 0
    s_waitcnt vmcnt(5)
    buffer_load_dwordx4 v[88:91], v2, s[28:31], s56 offen nt
    v_dot2c_f32_bf16_dpp v16, v28, v64 row_newbcast:0 row_mask:0xf bank_mask:0xf
    v_dot2c_f32_bf16_dpp v18, v28, v65 row_newbcast:0 row_mask:0xf bank_mask:0xf
    v_dot2c_f32_bf16_dpp v20, v28, v66 row_newbcast:0 row_mask:0xf bank_mask:0xf
    v_dot2c_f32_bf16_dpp v22, v28, v67 row_newbcast:0 row_mask:0xf bank_mask:0xf
    v_dot2c_f32_bf16_dpp v17, v29, v64 row_newbcast:0 row_mask:0xf bank_mask:0xf
    v_dot2c_f32_bf16_dpp v19, v29, v65 row_newbcast:0 row_mask:0xf bank_mask:0xf
    v_dot2c_f32_bf16_dpp v21, v29, v66 row_newbcast:0 row_mask:0xf bank_mask:0xf
    v_dot2c_f32_bf16_dpp v23, v29, v67 row_newbcast:0 row_mask:0xf bank_mask:0xf
    v_sub_f32 v222, v214, v40
    v_mul_f32 v222, s75, v222
    v_sub_f32 v223, v215, v40
    v_mul_f32 v223, s75, v223
    v_exp_f32 v222, v222
    v_exp_f32 v223, v223
    s_nop 0
    v_mul_f32 v214, v222, v46
    v_fma_f32 v222, -v214, v41, v222
    v_fma_f32 v214, v222, v46, v214
    v_cvt_pk_bf16_f32 v214, v214, 0
    ds_write_b32 v5, v214 offset:1536
    v_mul_f32 v215, v223, v46
    v_fma_f32 v223, -v215, v41, v223
    v_fma_f32 v215, v223, v46, v215
    v_cvt_pk_bf16_f32 v215, v215, 0
    ds_write_b32 v5, v215 offset:1792
    s_waitcnt vmcnt(5)
    v_dot2c_f32_bf16_dpp v8, v30, v68 row_newbcast:4 row_mask:0xf bank_mask:0xf
    v_dot2c_f32_bf16_dpp v10, v30, v69 row_newbcast:4 row_mask:0xf bank_mask:0xf
    v_dot2c_f32_bf16_dpp v12, v30, v70 row_newbcast:4 row_mask:0xf bank_mask:0xf
    v_dot2c_f32_bf16_dpp v14, v30, v71 row_newbcast:4 row_mask:0xf bank_mask:0xf
    v_dot2c_f32_bf16_dpp v9, v31, v68 row_newbcast:4 row_mask:0xf bank_mask:0xf
    v_dot2c_f32_bf16_dpp v11, v31, v69 row_newbcast:4 row_mask:0xf bank_mask:0xf
    v_dot2c_f32_bf16_dpp v13, v31, v70 row_newbcast:4 row_mask:0xf bank_mask:0xf
    v_dot2c_f32_bf16_dpp v15, v31, v71 row_newbcast:4 row_mask:0xf bank_mask:0xf
    s_waitcnt vmcnt(4)
    buffer_load_dwordx4 v[128:131], v4, s[36:39], s60 offen
    s_add_u32 s60, s60, 8192
    s_and_b32 s60, s60, 262143
    v_dot2c_f32_bf16_dpp v8, v30, v72 row_newbcast:5 row_mask:0xf bank_mask:0xf
    v_dot2c_f32_bf16_dpp v10, v30, v73 row_newbcast:5 row_mask:0xf bank_mask:0xf
    v_dot2c_f32_bf16_dpp v12, v30, v74 row_newbcast:5 row_mask:0xf bank_mask:0xf
    v_dot2c_f32_bf16_dpp v14, v30, v75 row_newbcast:5 row_mask:0xf bank_mask:0xf
    v_dot2c_f32_bf16_dpp v9, v31, v72 row_newbcast:5 row_mask:0xf bank_mask:0xf
    v_dot2c_f32_bf16_dpp v11, v31, v73 row_newbcast:5 row_mask:0xf bank_mask:0xf
    v_dot2c_f32_bf16_dpp v13, v31, v74 row_newbcast:5 row_mask:0xf bank_mask:0xf
    v_dot2c_f32_bf16_dpp v15, v31, v75 row_newbcast:5 row_mask:0xf bank_mask:0xf
    s_waitcnt vmcnt(4)
    buffer_load_dwordx4 v[92:95], v2, s[28:31], s56 offen offset:1024 nt
    v_dot2c_f32_bf16_dpp v8, v30, v76 row_newbcast:6 row_mask:0xf bank_mask:0xf
    v_dot2c_f32_bf16_dpp v10, v30, v77 row_newbcast:6 row_mask:0xf bank_mask:0xf
    v_dot2c_f32_bf16_dpp v12, v30, v78 row_newbcast:6 row_mask:0xf bank_mask:0xf
    v_dot2c_f32_bf16_dpp v14, v30, v79 row_newbcast:6 row_mask:0xf bank_mask:0xf
    v_dot2c_f32_bf16_dpp v9, v31, v76 row_newbcast:6 row_mask:0xf bank_mask:0xf
    v_dot2c_f32_bf16_dpp v11, v31, v77 row_newbcast:6 row_mask:0xf bank_mask:0xf
    v_dot2c_f32_bf16_dpp v13, v31, v78 row_newbcast:6 row_mask:0xf bank_mask:0xf
    v_dot2c_f32_bf16_dpp v15, v31, v79 row_newbcast:6 row_mask:0xf bank_mask:0xf
    s_waitcnt vmcnt(4)
    buffer_load_dwordx4 v[96:99], v2, s[28:31], s56 offen offset:2048 nt
    v_dot2c_f32_bf16_dpp v8, v30, v80 row_newbcast:7 row_mask:0xf bank_mask:0xf
    v_dot2c_f32_bf16_dpp v10, v30, v81 row_newbcast:7 row_mask:0xf bank_mask:0xf
    v_dot2c_f32_bf16_dpp v12, v30, v82 row_newbcast:7 row_mask:0xf bank_mask:0xf
    v_dot2c_f32_bf16_dpp v14, v30, v83 row_newbcast:7 row_mask:0xf bank_mask:0xf
    v_dot2c_f32_bf16_dpp v9, v31, v80 row_newbcast:7 row_mask:0xf bank_mask:0xf
    v_dot2c_f32_bf16_dpp v11, v31, v81 row_newbcast:7 row_mask:0xf bank_mask:0xf
    v_dot2c_f32_bf16_dpp v13, v31, v82 row_newbcast:7 row_mask:0xf bank_mask:0xf
    v_dot2c_f32_bf16_dpp v15, v31, v83 row_newbcast:7 row_mask:0xf bank_mask:0xf
    s_waitcnt vmcnt(4)
    buffer_load_dwordx4 v[100:103], v2, s[28:31], s56 offen offset:3072 nt
    s_add_u32 s56, s56, 32768
    v_dot2c_f32_bf16_dpp v16, v28, v84 row_newbcast:1 row_mask:0xf bank_mask:0xf
    v_dot2c_f32_bf16_dpp v18, v28, v85 row_newbcast:1 row_mask:0xf bank_mask:0xf
    v_dot2c_f32_bf16_dpp v20, v28, v86 row_newbcast:1 row_mask:0xf bank_mask:0xf
    v_dot2c_f32_bf16_dpp v22, v28, v87 row_newbcast:1 row_mask:0xf bank_mask:0xf
    v_dot2c_f32_bf16_dpp v17, v29, v84 row_newbcast:1 row_mask:0xf bank_mask:0xf
    v_dot2c_f32_bf16_dpp v19, v29, v85 row_newbcast:1 row_mask:0xf bank_mask:0xf
    v_dot2c_f32_bf16_dpp v21, v29, v86 row_newbcast:1 row_mask:0xf bank_mask:0xf
    v_dot2c_f32_bf16_dpp v23, v29, v87 row_newbcast:1 row_mask:0xf bank_mask:0xf
    s_waitcnt vmcnt(4)
    buffer_load_dwordx4 v[104:107], v3, s[32:35], s57 offen
    s_add_u32 s57, s57, s58
    s_cmp_ge_u32 s57, s76
    s_cselect_b32 s57, 0, s57
    v_dot2c_f32_bf16_dpp v8, v30, v88 row_newbcast:8 row_mask:0xf bank_mask:0xf
    v_dot2c_f32_bf16_dpp v10, v30, v89 row_newbcast:8 row_mask:0xf bank_mask:0xf
    v_dot2c_f32_bf16_dpp v12, v30, v90 row_newbcast:8 row_mask:0xf bank_mask:0xf
    v_dot2c_f32_bf16_dpp v14, v30, v91 row_newbcast:8 row_mask:0xf bank_mask:0xf
    v_dot2c_f32_bf16_dpp v9, v31, v88 row_newbcast:8 row_mask:0xf bank_mask:0xf
    v_dot2c_f32_bf16_dpp v11, v31, v89 row_newbcast:8 row_mask:0xf bank_mask:0xf
    v_dot2c_f32_bf16_dpp v13, v31, v90 row_newbcast:8 row_mask:0xf bank_mask:0xf
    v_dot2c_f32_bf16_dpp v15, v31, v91 row_newbcast:8 row_mask:0xf bank_mask:0xf
    s_waitcnt vmcnt(3)
    buffer_load_dwordx4 v[108:111], v2, s[28:31], s56 offen nt
    buffer_load_dwordx4 v[132:135], v4, s[36:39], s60 offen
    s_add_u32 s60, s60, 8192
    s_and_b32 s60, s60, 262143
    v_dot2c_f32_bf16_dpp v8, v30, v92 row_newbcast:9 row_mask:0xf bank_mask:0xf
    v_dot2c_f32_bf16_dpp v10, v30, v93 row_newbcast:9 row_mask:0xf bank_mask:0xf
    v_dot2c_f32_bf16_dpp v12, v30, v94 row_newbcast:9 row_mask:0xf bank_mask:0xf
    v_dot2c_f32_bf16_dpp v14, v30, v95 row_newbcast:9 row_mask:0xf bank_mask:0xf
    v_dot2c_f32_bf16_dpp v9, v31, v92 row_newbcast:9 row_mask:0xf bank_mask:0xf
    v_dot2c_f32_bf16_dpp v11, v31, v93 row_newbcast:9 row_mask:0xf bank_mask:0xf
    v_dot2c_f32_bf16_dpp v13, v31, v94 row_newbcast:9 row_mask:0xf bank_mask:0xf
    v_dot2c_f32_bf16_dpp v15, v31, v95 row_newbcast:9 row_mask:0xf bank_mask:0xf
    s_waitcnt vmcnt(4)
    buffer_load_dwordx4 v[112:115], v2, s[28:31], s56 offen offset:1024 nt
    v_dot2c_f32_bf16_dpp v8, v30, v96 row_newbcast:10 row_mask:0xf bank_mask:0xf
    v_dot2c_f32_bf16_dpp v10, v30, v97 row_newbcast:10 row_mask:0xf bank_mask:0xf
    v_dot2c_f32_bf16_dpp v12, v30, v98 row_newbcast:10 row_mask:0xf bank_mask:0xf
    v_dot2c_f32_bf16_dpp v14, v30, v99 row_newbcast:10 row_mask:0xf bank_mask:0xf
    v_dot2c_f32_bf16_dpp v9, v31, v96 row_newbcast:10 row_mask:0xf bank_mask:0xf
    v_dot2c_f32_bf16_dpp v11, v31, v97 row_newbcast:10 row_mask:0xf bank_mask:0xf
    v_dot2c_f32_bf16_dpp v13, v31, v98 row_newbcast:10 row_mask:0xf bank_mask:0xf
    v_dot2c_f32_bf16_dpp v15, v31, v99 row_newbcast:10 row_mask:0xf bank_mask:0xf
    s_waitcnt vmcnt(4)
    buffer_load_dwordx4 v[116:119], v2, s[28:31], s56 offen offset:2048 nt
    v_dot2c_f32_bf16_dpp v8, v30, v100 row_newbcast:11 row_mask:0xf bank_mask:0xf
    v_dot2c_f32_bf16_dpp v10, v30, v101 row_newbcast:11 row_mask:0xf bank_mask:0xf
    v_dot2c_f32_bf16_dpp v12, v30, v102 row_newbcast:11 row_mask:0xf bank_mask:0xf
    v_dot2c_f32_bf16_dpp v14, v30, v103 row_newbcast:11 row_mask:0xf bank_mask:0xf
    v_dot2c_f32_bf16_dpp v9, v31, v100 row_newbcast:11 row_mask:0xf bank_mask:0xf
    v_dot2c_f32_bf16_dpp v11, v31, v101 row_newbcast:11 row_mask:0xf bank_mask:0xf
    v_dot2c_f32_bf16_dpp v13, v31, v102 row_newbcast:11 row_mask:0xf bank_mask:0xf
    v_dot2c_f32_bf16_dpp v15, v31, v103 row_newbcast:11 row_mask:0xf bank_mask:0xf
    s_waitcnt vmcnt(4)
    buffer_load_dwordx4 v[120:123], v2, s[28:31], s56 offen offset:3072 nt
    s_add_u32 s56, s56, 32768
    v_dot2c_f32_bf16_dpp v16, v28, v104 row_newbcast:2 row_mask:0xf bank_mask:0xf
    v_dot2c_f32_bf16_dpp v18, v28, v105 row_newbcast:2 row_mask:0xf bank_mask:0xf
    v_dot2c_f32_bf16_dpp v20, v28, v106 row_newbcast:2 row_mask:0xf bank_mask:0xf
    v_dot2c_f32_bf16_dpp v22, v28, v107 row_newbcast:2 row_mask:0xf bank_mask:0xf
    v_dot2c_f32_bf16_dpp v17, v29, v104 row_newbcast:2 row_mask:0xf bank_mask:0xf
    v_dot2c_f32_bf16_dpp v19, v29, v105 row_newbcast:2 row_mask:0xf bank_mask:0xf
    v_dot2c_f32_bf16_dpp v21, v29, v106 row_newbcast:2 row_mask:0xf bank_mask:0xf
    v_dot2c_f32_bf16_dpp v23, v29, v107 row_newbcast:2 row_mask:0xf bank_mask:0xf
    s_waitcnt vmcnt(4)
    buffer_load_dwordx4 v[124:127], v3, s[32:35], s57 offen
    s_add_u32 s57, s57, s58
    s_cmp_ge_u32 s57, s76
    s_cselect_b32 s57, 0, s57
    v_dot2c_f32_bf16_dpp v8, v30, v108 row_newbcast:12 row_mask:0xf bank_mask:0xf
    v_dot2c_f32_bf16_dpp v10, v30, v109 row_newbcast:12 row_mask:0xf bank_mask:0xf
    v_dot2c_f32_bf16_dpp v12, v30, v110 row_newbcast:12 row_mask:0xf bank_mask:0xf
    v_dot2c_f32_bf16_dpp v14, v30, v111 row_newbcast:12 row_mask:0xf bank_mask:0xf
    v_dot2c_f32_bf16_dpp v9, v31, v108 row_newbcast:12 row_mask:0xf bank_mask:0xf
    v_dot2c_f32_bf16_dpp v11, v31, v109 row_newbcast:12 row_mask:0xf bank_mask:0xf
    v_dot2c_f32_bf16_dpp v13, v31, v110 row_newbcast:12 row_mask:0xf bank_mask:0xf
    v_dot2c_f32_bf16_dpp v15, v31, v111 row_newbcast:12 row_mask:0xf bank_mask:0xf
    s_waitcnt vmcnt(3)
    buffer_load_dwordx4 v[48:51], v2, s[28:31], s56 offen nt
    buffer_load_dwordx4 v[136:139], v4, s[36:39], s60 offen
    s_add_u32 s60, s60, 8192
    s_and_b32 s60, s60, 262143
    v_dot2c_f32_bf16_dpp v8, v30, v112 row_newbcast:13 row_mask:0xf bank_mask:0xf
    v_dot2c_f32_bf16_dpp v10, v30, v113 row_newbcast:13 row_mask:0xf bank_mask:0xf
    v_dot2c_f32_bf16_dpp v12, v30, v114 row_newbcast:13 row_mask:0xf bank_mask:0xf
    v_dot2c_f32_bf16_dpp v14, v30, v115 row_newbcast:13 row_mask:0xf bank_mask:0xf
    v_dot2c_f32_bf16_dpp v9, v31, v112 row_newbcast:13 row_mask:0xf bank_mask:0xf
    v_dot2c_f32_bf16_dpp v11, v31, v113 row_newbcast:13 row_mask:0xf bank_mask:0xf
    v_dot2c_f32_bf16_dpp v13, v31, v114 row_newbcast:13 row_mask:0xf bank_mask:0xf
    v_dot2c_f32_bf16_dpp v15, v31, v115 row_newbcast:13 row_mask:0xf bank_mask:0xf
    v_perm_b32 v33, v132, v128, s77
    v_perm_b32 v132, v132, v128, s61
    s_waitcnt vmcnt(4)
    buffer_load_dwordx4 v[52:55], v2, s[28:31], s56 offen offset:1024 nt
    v_dot2c_f32_bf16_dpp v8, v30, v116 row_newbcast:14 row_mask:0xf bank_mask:0xf
    v_dot2c_f32_bf16_dpp v10, v30, v117 row_newbcast:14 row_mask:0xf bank_mask:0xf
    v_dot2c_f32_bf16_dpp v12, v30, v118 row_newbcast:14 row_mask:0xf bank_mask:0xf
    v_dot2c_f32_bf16_dpp v14, v30, v119 row_newbcast:14 row_mask:0xf bank_mask:0xf
    v_dot2c_f32_bf16_dpp v9, v31, v116 row_newbcast:14 row_mask:0xf bank_mask:0xf
    v_dot2c_f32_bf16_dpp v11, v31, v117 row_newbcast:14 row_mask:0xf bank_mask:0xf
    v_dot2c_f32_bf16_dpp v13, v31, v118 row_newbcast:14 row_mask:0xf bank_mask:0xf
    v_dot2c_f32_bf16_dpp v15, v31, v119 row_newbcast:14 row_mask:0xf bank_mask:0xf
    v_perm_b32 v128, v133, v129, s77
    v_perm_b32 v133, v133, v129, s61
    s_waitcnt vmcnt(4)
    buffer_load_dwordx4 v[56:59], v2, s[28:31], s56 offen offset:2048 nt
    v_dot2c_f32_bf16_dpp v8, v30, v120 row_newbcast:15 row_mask:0xf bank_mask:0xf
    v_dot2c_f32_bf16_dpp v10, v30, v121 row_newbcast:15 row_mask:0xf bank_mask:0xf
    v_dot2c_f32_bf16_dpp v12, v30, v122 row_newbcast:15 row_mask:0xf bank_mask:0xf
    v_dot2c_f32_bf16_dpp v14, v30, v123 row_newbcast:15 row_mask:0xf bank_mask:0xf
    v_dot2c_f32_bf16_dpp v9, v31, v120 row_newbcast:15 row_mask:0xf bank_mask:0xf
    v_dot2c_f32_bf16_dpp v11, v31, v121 row_newbcast:15 row_mask:0xf bank_mask:0xf
    v_dot2c_f32_bf16_dpp v13, v31, v122 row_newbcast:15 row_mask:0xf bank_mask:0xf
    v_dot2c_f32_bf16_dpp v15, v31, v123 row_newbcast:15 row_mask:0xf bank_mask:0xf
    v_perm_b32 v129, v134, v130, s77
    v_perm_b32 v134, v134, v130, s61
    s_waitcnt vmcnt(4)
    buffer_load_dwordx4 v[60:63], v2, s[28:31], s56 offen offset:3072 nt
    s_add_u32 s56, s56, 32768
    buffer_load_dwordx4 v[140:143], v4, s[36:39], s60 offen
    s_add_u32 s60, s60, 8192
    s_and_b32 s60, s60, 262143
    v_dot2c_f32_bf16_dpp v16, v28, v124 row_newbcast:3 row_mask:0xf bank_mask:0xf
    v_dot2c_f32_bf16_dpp v18, v28, v125 row_newbcast:3 row_mask:0xf bank_mask:0xf
    v_dot2c_f32_bf16_dpp v20, v28, v126 row_newbcast:3 row_mask:0xf bank_mask:0xf
    v_dot2c_f32_bf16_dpp v22, v28, v127 row_newbcast:3 row_mask:0xf bank_mask:0xf
    v_dot2c_f32_bf16_dpp v17, v29, v124 row_newbcast:3 row_mask:0xf bank_mask:0xf
    v_dot2c_f32_bf16_dpp v19, v29, v125 row_newbcast:3 row_mask:0xf bank_mask:0xf
    v_dot2c_f32_bf16_dpp v21, v29, v126 row_newbcast:3 row_mask:0xf bank_mask:0xf
    v_dot2c_f32_bf16_dpp v23, v29, v127 row_newbcast:3 row_mask:0xf bank_mask:0xf
    v_perm_b32 v130, v135, v131, s77
    v_perm_b32 v135, v135, v131, s61
    v_add_u32 v5, 256, v5
    s_barrier
    s_waitcnt lgkmcnt(0)
    ds_read_b32 v30, v5
    ds_read_b32 v28, v6
    v_add_u32 v5, 256, v5
    v_add_u32 v6, 64, v6
    v_and_or_b32 v6, v6, s95, v1
    s_waitcnt lgkmcnt(0)
    v_lshlrev_b32 v31, 16, v30
    v_lshlrev_b32 v29, 16, v28
    s_waitcnt vmcnt(5)
    buffer_load_dwordx4 v[64:67], v3, s[32:35], s57 offen
    s_add_u32 s57, s57, s58
    s_cmp_ge_u32 s57, s76
    s_cselect_b32 s57, 0, s57
    v_dot2c_f32_bf16_dpp v8, v30, v48 row_newbcast:0 row_mask:0xf bank_mask:0xf
    v_dot2c_f32_bf16_dpp v10, v30, v49 row_newbcast:0 row_mask:0xf bank_mask:0xf
    v_dot2c_f32_bf16_dpp v12, v30, v50 row_newbcast:0 row_mask:0xf bank_mask:0xf
    v_dot2c_f32_bf16_dpp v14, v30, v51 row_newbcast:0 row_mask:0xf bank_mask:0xf
    v_dot2c_f32_bf16_dpp v9, v31, v48 row_newbcast:0 row_mask:0xf bank_mask:0xf
    v_dot2c_f32_bf16_dpp v11, v31, v49 row_newbcast:0 row_mask:0xf bank_mask:0xf
    v_dot2c_f32_bf16_dpp v13, v31, v50 row_newbcast:0 row_mask:0xf bank_mask:0xf
    v_dot2c_f32_bf16_dpp v15, v31, v51 row_newbcast:0 row_mask:0xf bank_mask:0xf
    s_waitcnt vmcnt(4)
    buffer_load_dwordx4 v[144:147], v4, s[36:39], s60 offen
    s_add_u32 s60, s60, 8192
    s_and_b32 s60, s60, 262143
    v_dot2c_f32_bf16_dpp v8, v30, v52 row_newbcast:1 row_mask:0xf bank_mask:0xf
    v_dot2c_f32_bf16_dpp v10, v30, v53 row_newbcast:1 row_mask:0xf bank_mask:0xf
    v_dot2c_f32_bf16_dpp v12, v30, v54 row_newbcast:1 row_mask:0xf bank_mask:0xf
    v_dot2c_f32_bf16_dpp v14, v30, v55 row_newbcast:1 row_mask:0xf bank_mask:0xf
    v_dot2c_f32_bf16_dpp v9, v31, v52 row_newbcast:1 row_mask:0xf bank_mask:0xf
    v_dot2c_f32_bf16_dpp v11, v31, v53 row_newbcast:1 row_mask:0xf bank_mask:0xf
    v_dot2c_f32_bf16_dpp v13, v31, v54 row_newbcast:1 row_mask:0xf bank_mask:0xf
    v_dot2c_f32_bf16_dpp v15, v31, v55 row_newbcast:1 row_mask:0xf bank_mask:0xf
    s_waitcnt vmcnt(4)
    buffer_load_dwordx4 v[68:71], v2, s[28:31], s56 offen nt
    buffer_load_dwordx4 v[72:75], v2, s[28:31], s56 offen offset:1024 nt
    v_dot2c_f32_bf16_dpp v8, v30, v56 row_newbcast:2 row_mask:0xf bank_mask:0xf
    v_dot2c_f32_bf16_dpp v10, v30, v57 row_newbcast:2 row_mask:0xf bank_mask:0xf
    v_dot2c_f32_bf16_dpp v12, v30, v58 row_newbcast:2 row_mask:0xf bank_mask:0xf
    v_dot2c_f32_bf16_dpp v14, v30, v59 row_newbcast:2 row_mask:0xf bank_mask:0xf
    v_dot2c_f32_bf16_dpp v9, v31, v56 row_newbcast:2 row_mask:0xf bank_mask:0xf
    v_dot2c_f32_bf16_dpp v11, v31, v57 row_newbcast:2 row_mask:0xf bank_mask:0xf
    v_dot2c_f32_bf16_dpp v13, v31, v58 row_newbcast:2 row_mask:0xf bank_mask:0xf
    v_dot2c_f32_bf16_dpp v15, v31, v59 row_newbcast:2 row_mask:0xf bank_mask:0xf
    s_waitcnt vmcnt(5)
    v_dot2c_f32_bf16_dpp v8, v30, v60 row_newbcast:3 row_mask:0xf bank_mask:0xf
    v_dot2c_f32_bf16_dpp v10, v30, v61 row_newbcast:3 row_mask:0xf bank_mask:0xf
    v_dot2c_f32_bf16_dpp v12, v30, v62 row_newbcast:3 row_mask:0xf bank_mask:0xf
    v_dot2c_f32_bf16_dpp v14, v30, v63 row_newbcast:3 row_mask:0xf bank_mask:0xf
    v_dot2c_f32_bf16_dpp v9, v31, v60 row_newbcast:3 row_mask:0xf bank_mask:0xf
    v_dot2c_f32_bf16_dpp v11, v31, v61 row_newbcast:3 row_mask:0xf bank_mask:0xf
    v_dot2c_f32_bf16_dpp v13, v31, v62 row_newbcast:3 row_mask:0xf bank_mask:0xf
    v_dot2c_f32_bf16_dpp v15, v31, v63 row_newbcast:3 row_mask:0xf bank_mask:0xf
    s_waitcnt vmcnt(3)
    buffer_load_dwordx4 v[76:79], v2, s[28:31], s56 offen offset:2048 nt
    buffer_load_dwordx4 v[80:83], v2, s[28:31], s56 offen offset:3072 nt
    s_add_u32 s56, s56, 32768
    v_dot2c_f32_bf16_dpp v16, v28, v64 row_newbcast:0 row_mask:0xf bank_mask:0xf
    v_dot2c_f32_bf16_dpp v18, v28, v65 row_newbcast:0 row_mask:0xf bank_mask:0xf
    v_dot2c_f32_bf16_dpp v20, v28, v66 row_newbcast:0 row_mask:0xf bank_mask:0xf
    v_dot2c_f32_bf16_dpp v22, v28, v67 row_newbcast:0 row_mask:0xf bank_mask:0xf
    v_dot2c_f32_bf16_dpp v17, v29, v64 row_newbcast:0 row_mask:0xf bank_mask:0xf
    v_dot2c_f32_bf16_dpp v19, v29, v65 row_newbcast:0 row_mask:0xf bank_mask:0xf
    v_dot2c_f32_bf16_dpp v21, v29, v66 row_newbcast:0 row_mask:0xf bank_mask:0xf
    v_dot2c_f32_bf16_dpp v23, v29, v67 row_newbcast:0 row_mask:0xf bank_mask:0xf
    v_perm_b32 v131, v140, v136, s77
    v_perm_b32 v140, v140, v136, s61
    s_waitcnt vmcnt(3)
    buffer_load_dwordx4 v[148:151], v4, s[36:39], s60 offen
    s_add_u32 s60, s60, 8192
    s_and_b32 s60, s60, 262143
    v_dot2c_f32_bf16_dpp v8, v30, v68 row_newbcast:4 row_mask:0xf bank_mask:0xf
    v_dot2c_f32_bf16_dpp v10, v30, v69 row_newbcast:4 row_mask:0xf bank_mask:0xf
    v_dot2c_f32_bf16_dpp v12, v30, v70 row_newbcast:4 row_mask:0xf bank_mask:0xf
    v_dot2c_f32_bf16_dpp v14, v30, v71 row_newbcast:4 row_mask:0xf bank_mask:0xf
    v_dot2c_f32_bf16_dpp v9, v31, v68 row_newbcast:4 row_mask:0xf bank_mask:0xf
    v_dot2c_f32_bf16_dpp v11, v31, v69 row_newbcast:4 row_mask:0xf bank_mask:0xf
    v_dot2c_f32_bf16_dpp v13, v31, v70 row_newbcast:4 row_mask:0xf bank_mask:0xf
    v_dot2c_f32_bf16_dpp v15, v31, v71 row_newbcast:4 row_mask:0xf bank_mask:0xf
    v_perm_b32 v136, v141, v137, s77
    v_perm_b32 v141, v141, v137, s61
    s_waitcnt vmcnt(3)
    buffer_load_dwordx4 v[84:87], v3, s[32:35], s57 offen
    s_add_u32 s57, s57, s58
    s_cmp_ge_u32 s57, s76
    s_cselect_b32 s57, 0, s57
    buffer_load_dwordx4 v[88:91], v2, s[28:31], s56 offen nt
    v_dot2c_f32_bf16_dpp v8, v30, v72 row_newbcast:5 row_mask:0xf bank_mask:0xf
    v_dot2c_f32_bf16_dpp v10, v30, v73 row_newbcast:5 row_mask:0xf bank_mask:0xf
    v_dot2c_f32_bf16_dpp v12, v30, v74 row_newbcast:5 row_mask:0xf bank_mask:0xf
    v_dot2c_f32_bf16_dpp v14, v30, v75 row_newbcast:5 row_mask:0xf bank_mask:0xf
    v_dot2c_f32_bf16_dpp v9, v31, v72 row_newbcast:5 row_mask:0xf bank_mask:0xf
    v_dot2c_f32_bf16_dpp v11, v31, v73 row_newbcast:5 row_mask:0xf bank_mask:0xf
    v_dot2c_f32_bf16_dpp v13, v31, v74 row_newbcast:5 row_mask:0xf bank_mask:0xf
    v_dot2c_f32_bf16_dpp v15, v31, v75 row_newbcast:5 row_mask:0xf bank_mask:0xf
    v_perm_b32 v137, v142, v138, s77
    v_perm_b32 v142, v142, v138, s61
    s_waitcnt vmcnt(4)
    v_dot2c_f32_bf16_dpp v8, v30, v76 row_newbcast:6 row_mask:0xf bank_mask:0xf
    v_dot2c_f32_bf16_dpp v10, v30, v77 row_newbcast:6 row_mask:0xf bank_mask:0xf
    v_dot2c_f32_bf16_dpp v12, v30, v78 row_newbcast:6 row_mask:0xf bank_mask:0xf
    v_dot2c_f32_bf16_dpp v14, v30, v79 row_newbcast:6 row_mask:0xf bank_mask:0xf
    v_dot2c_f32_bf16_dpp v9, v31, v76 row_newbcast:6 row_mask:0xf bank_mask:0xf
    v_dot2c_f32_bf16_dpp v11, v31, v77 row_newbcast:6 row_mask:0xf bank_mask:0xf
    v_dot2c_f32_bf16_dpp v13, v31, v78 row_newbcast:6 row_mask:0xf bank_mask:0xf
    v_dot2c_f32_bf16_dpp v15, v31, v79 row_newbcast:6 row_mask:0xf bank_mask:0xf
    v_perm_b32 v138, v143, v139, s77
    v_perm_b32 v143, v143, v139, s61
    s_waitcnt vmcnt(3)
    buffer_load_dwordx4 v[92:95], v2, s[28:31], s56 offen offset:1024 nt
    buffer_load_dwordx4 v[96:99], v2, s[28:31], s56 offen offset:2048 nt
    v_dot2c_f32_bf16_dpp v8, v30, v80 row_newbcast:7 row_mask:0xf bank_mask:0xf
    v_dot2c_f32_bf16_dpp v10, v30, v81 row_newbcast:7 row_mask:0xf bank_mask:0xf
    v_dot2c_f32_bf16_dpp v12, v30, v82 row_newbcast:7 row_mask:0xf bank_mask:0xf
    v_dot2c_f32_bf16_dpp v14, v30, v83 row_newbcast:7 row_mask:0xf bank_mask:0xf
    v_dot2c_f32_bf16_dpp v9, v31, v80 row_newbcast:7 row_mask:0xf bank_mask:0xf
    v_dot2c_f32_bf16_dpp v11, v31, v81 row_newbcast:7 row_mask:0xf bank_mask:0xf
    v_dot2c_f32_bf16_dpp v13, v31, v82 row_newbcast:7 row_mask:0xf bank_mask:0xf
    v_dot2c_f32_bf16_dpp v15, v31, v83 row_newbcast:7 row_mask:0xf bank_mask:0xf
    s_waitcnt vmcnt(3)
    buffer_load_dwordx4 v[152:155], v4, s[36:39], s60 offen
    s_add_u32 s60, s60, 8192
    s_and_b32 s60, s60, 262143
    v_dot2c_f32_bf16_dpp v16, v28, v84 row_newbcast:1 row_mask:0xf bank_mask:0xf
    v_dot2c_f32_bf16_dpp v18, v28, v85 row_newbcast:1 row_mask:0xf bank_mask:0xf
    v_dot2c_f32_bf16_dpp v20, v28, v86 row_newbcast:1 row_mask:0xf bank_mask:0xf
    v_dot2c_f32_bf16_dpp v22, v28, v87 row_newbcast:1 row_mask:0xf bank_mask:0xf
    v_dot2c_f32_bf16_dpp v17, v29, v84 row_newbcast:1 row_mask:0xf bank_mask:0xf
    v_dot2c_f32_bf16_dpp v19, v29, v85 row_newbcast:1 row_mask:0xf bank_mask:0xf
    v_dot2c_f32_bf16_dpp v21, v29, v86 row_newbcast:1 row_mask:0xf bank_mask:0xf
    v_dot2c_f32_bf16_dpp v23, v29, v87 row_newbcast:1 row_mask:0xf bank_mask:0xf
    v_perm_b32 v139, v148, v144, s77
    v_perm_b32 v148, v148, v144, s61
    s_waitcnt vmcnt(3)
    buffer_load_dwordx4 v[100:103], v2, s[28:31], s56 offen offset:3072 nt
    s_add_u32 s56, s56, 32768
    buffer_load_dwordx4 v[104:107], v3, s[32:35], s57 offen
    s_add_u32 s57, s57, s58
    s_cmp_ge_u32 s57, s76
    s_cselect_b32 s57, 0, s57
    v_dot2c_f32_bf16_dpp v8, v30, v88 row_newbcast:8 row_mask:0xf bank_mask:0xf
    v_dot2c_f32_bf16_dpp v10, v30, v89 row_newbcast:8 row_mask:0xf bank_mask:0xf
    v_dot2c_f32_bf16_dpp v12, v30, v90 row_newbcast:8 row_mask:0xf bank_mask:0xf
    v_dot2c_f32_bf16_dpp v14, v30, v91 row_newbcast:8 row_mask:0xf bank_mask:0xf
    v_dot2c_f32_bf16_dpp v9, v31, v88 row_newbcast:8 row_mask:0xf bank_mask:0xf
    v_dot2c_f32_bf16_dpp v11, v31, v89 row_newbcast:8 row_mask:0xf bank_mask:0xf
    v_dot2c_f32_bf16_dpp v13, v31, v90 row_newbcast:8 row_mask:0xf bank_mask:0xf
    v_dot2c_f32_bf16_dpp v15, v31, v91 row_newbcast:8 row_mask:0xf bank_mask:0xf
    v_perm_b32 v144, v149, v145, s77
    v_perm_b32 v149, v149, v145, s61
    s_waitcnt vmcnt(4)
    v_dot2c_f32_bf16_dpp v8, v30, v92 row_newbcast:9 row_mask:0xf bank_mask:0xf
    v_dot2c_f32_bf16_dpp v10, v30, v93 row_newbcast:9 row_mask:0xf bank_mask:0xf
    v_dot2c_f32_bf16_dpp v12, v30, v94 row_newbcast:9 row_mask:0xf bank_mask:0xf
    v_dot2c_f32_bf16_dpp v14, v30, v95 row_newbcast:9 row_mask:0xf bank_mask:0xf
    v_dot2c_f32_bf16_dpp v9, v31, v92 row_newbcast:9 row_mask:0xf bank_mask:0xf
    v_dot2c_f32_bf16_dpp v11, v31, v93 row_newbcast:9 row_mask:0xf bank_mask:0xf
    v_dot2c_f32_bf16_dpp v13, v31, v94 row_newbcast:9 row_mask:0xf bank_mask:0xf
    v_dot2c_f32_bf16_dpp v15, v31, v95 row_newbcast:9 row_mask:0xf bank_mask:0xf
    v_perm_b32 v145, v150, v146, s77
    v_perm_b32 v150, v150, v146, s61
    s_waitcnt vmcnt(3)
    buffer_load_dwordx4 v[108:111], v2, s[28:31], s56 offen nt
    buffer_load_dwordx4 v[112:115], v2, s[28:31], s56 offen offset:1024 nt
    v_dot2c_f32_bf16_dpp v8, v30, v96 row_newbcast:10 row_mask:0xf bank_mask:0xf
    v_dot2c_f32_bf16_dpp v10, v30, v97 row_newbcast:10 row_mask:0xf bank_mask:0xf
    v_dot2c_f32_bf16_dpp v12, v30, v98 row_newbcast:10 row_mask:0xf bank_mask:0xf
    v_dot2c_f32_bf16_dpp v14, v30, v99 row_newbcast:10 row_mask:0xf bank_mask:0xf
    v_dot2c_f32_bf16_dpp v9, v31, v96 row_newbcast:10 row_mask:0xf bank_mask:0xf
    v_dot2c_f32_bf16_dpp v11, v31, v97 row_newbcast:10 row_mask:0xf bank_mask:0xf
    v_dot2c_f32_bf16_dpp v13, v31, v98 row_newbcast:10 row_mask:0xf bank_mask:0xf
    v_dot2c_f32_bf16_dpp v15, v31, v99 row_newbcast:10 row_mask:0xf bank_mask:0xf
    v_perm_b32 v146, v151, v147, s77
    v_perm_b32 v151, v151, v147, s61
    s_waitcnt vmcnt(3)
    buffer_load_dwordx4 v[156:159], v4, s[36:39], s60 offen
    s_add_u32 s60, s60, 8192
    s_and_b32 s60, s60, 262143
    v_dot2c_f32_bf16_dpp v8, v30, v100 row_newbcast:11 row_mask:0xf bank_mask:0xf
    v_dot2c_f32_bf16_dpp v10, v30, v101 row_newbcast:11 row_mask:0xf bank_mask:0xf
    v_dot2c_f32_bf16_dpp v12, v30, v102 row_newbcast:11 row_mask:0xf bank_mask:0xf
    v_dot2c_f32_bf16_dpp v14, v30, v103 row_newbcast:11 row_mask:0xf bank_mask:0xf
    v_dot2c_f32_bf16_dpp v9, v31, v100 row_newbcast:11 row_mask:0xf bank_mask:0xf
    v_dot2c_f32_bf16_dpp v11, v31, v101 row_newbcast:11 row_mask:0xf bank_mask:0xf
    v_dot2c_f32_bf16_dpp v13, v31, v102 row_newbcast:11 row_mask:0xf bank_mask:0xf
    v_dot2c_f32_bf16_dpp v15, v31, v103 row_newbcast:11 row_mask:0xf bank_mask:0xf
    s_waitcnt vmcnt(3)
    buffer_load_dwordx4 v[116:119], v2, s[28:31], s56 offen offset:2048 nt
    buffer_load_dwordx4 v[120:123], v2, s[28:31], s56 offen offset:3072 nt
    s_add_u32 s56, s56, 32768
    v_dot2c_f32_bf16_dpp v16, v28, v104 row_newbcast:2 row_mask:0xf bank_mask:0xf
    v_dot2c_f32_bf16_dpp v18, v28, v105 row_newbcast:2 row_mask:0xf bank_mask:0xf
    v_dot2c_f32_bf16_dpp v20, v28, v106 row_newbcast:2 row_mask:0xf bank_mask:0xf
    v_dot2c_f32_bf16_dpp v22, v28, v107 row_newbcast:2 row_mask:0xf bank_mask:0xf
    v_dot2c_f32_bf16_dpp v17, v29, v104 row_newbcast:2 row_mask:0xf bank_mask:0xf
    v_dot2c_f32_bf16_dpp v19, v29, v105 row_newbcast:2 row_mask:0xf bank_mask:0xf
    v_dot2c_f32_bf16_dpp v21, v29, v106 row_newbcast:2 row_mask:0xf bank_mask:0xf
    v_dot2c_f32_bf16_dpp v23, v29, v107 row_newbcast:2 row_mask:0xf bank_mask:0xf
    s_waitcnt vmcnt(4)
    v_dot2c_f32_bf16_dpp v8, v30, v108 row_newbcast:12 row_mask:0xf bank_mask:0xf
    v_dot2c_f32_bf16_dpp v10, v30, v109 row_newbcast:12 row_mask:0xf bank_mask:0xf
    v_dot2c_f32_bf16_dpp v12, v30, v110 row_newbcast:12 row_mask:0xf bank_mask:0xf
    v_dot2c_f32_bf16_dpp v14, v30, v111 row_newbcast:12 row_mask:0xf bank_mask:0xf
    v_dot2c_f32_bf16_dpp v9, v31, v108 row_newbcast:12 row_mask:0xf bank_mask:0xf
    v_dot2c_f32_bf16_dpp v11, v31, v109 row_newbcast:12 row_mask:0xf bank_mask:0xf
    v_dot2c_f32_bf16_dpp v13, v31, v110 row_newbcast:12 row_mask:0xf bank_mask:0xf
    v_dot2c_f32_bf16_dpp v15, v31, v111 row_newbcast:12 row_mask:0xf bank_mask:0xf
    s_waitcnt vmcnt(3)
    buffer_load_dwordx4 v[124:127], v3, s[32:35], s57 offen
    s_add_u32 s57, s57, s58
    s_cmp_ge_u32 s57, s76
    s_cselect_b32 s57, 0, s57
    buffer_load_dwordx4 v[48:51], v2, s[28:31], s56 offen nt
    v_dot2c_f32_bf16_dpp v8, v30, v112 row_newbcast:13 row_mask:0xf bank_mask:0xf
    v_dot2c_f32_bf16_dpp v10, v30, v113 row_newbcast:13 row_mask:0xf bank_mask:0xf
    v_dot2c_f32_bf16_dpp v12, v30, v114 row_newbcast:13 row_mask:0xf bank_mask:0xf
    v_dot2c_f32_bf16_dpp v14, v30, v115 row_newbcast:13 row_mask:0xf bank_mask:0xf
    v_dot2c_f32_bf16_dpp v9, v31, v112 row_newbcast:13 row_mask:0xf bank_mask:0xf
    v_dot2c_f32_bf16_dpp v11, v31, v113 row_newbcast:13 row_mask:0xf bank_mask:0xf
    v_dot2c_f32_bf16_dpp v13, v31, v114 row_newbcast:13 row_mask:0xf bank_mask:0xf
    v_dot2c_f32_bf16_dpp v15, v31, v115 row_newbcast:13 row_mask:0xf bank_mask:0xf
    s_waitcnt vmcnt(3)
    buffer_load_dwordx4 v[160:163], v4, s[36:39], s60 offen
    s_add_u32 s60, s60, 8192
    s_and_b32 s60, s60, 262143
    v_dot2c_f32_bf16_dpp v8, v30, v116 row_newbcast:14 row_mask:0xf bank_mask:0xf
    v_dot2c_f32_bf16_dpp v10, v30, v117 row_newbcast:14 row_mask:0xf bank_mask:0xf
    v_dot2c_f32_bf16_dpp v12, v30, v118 row_newbcast:14 row_mask:0xf bank_mask:0xf
    v_dot2c_f32_bf16_dpp v14, v30, v119 row_newbcast:14 row_mask:0xf bank_mask:0xf
    v_dot2c_f32_bf16_dpp v9, v31, v116 row_newbcast:14 row_mask:0xf bank_mask:0xf
    v_dot2c_f32_bf16_dpp v11, v31, v117 row_newbcast:14 row_mask:0xf bank_mask:0xf
    v_dot2c_f32_bf16_dpp v13, v31, v118 row_newbcast:14 row_mask:0xf bank_mask:0xf
    v_dot2c_f32_bf16_dpp v15, v31, v119 row_newbcast:14 row_mask:0xf bank_mask:0xf
    v_perm_b32 v147, v156, v152, s77
    v_perm_b32 v156, v156, v152, s61
    s_waitcnt vmcnt(3)
    buffer_load_dwordx4 v[52:55], v2, s[28:31], s56 offen offset:1024 nt
    buffer_load_dwordx4 v[56:59], v2, s[28:31], s56 offen offset:2048 nt
    v_dot2c_f32_bf16_dpp v8, v30, v120 row_newbcast:15 row_mask:0xf bank_mask:0xf
    v_dot2c_f32_bf16_dpp v10, v30, v121 row_newbcast:15 row_mask:0xf bank_mask:0xf
    v_dot2c_f32_bf16_dpp v12, v30, v122 row_newbcast:15 row_mask:0xf bank_mask:0xf
    v_dot2c_f32_bf16_dpp v14, v30, v123 row_newbcast:15 row_mask:0xf bank_mask:0xf
    v_dot2c_f32_bf16_dpp v9, v31, v120 row_newbcast:15 row_mask:0xf bank_mask:0xf
    v_dot2c_f32_bf16_dpp v11, v31, v121 row_newbcast:15 row_mask:0xf bank_mask:0xf
    v_dot2c_f32_bf16_dpp v13, v31, v122 row_newbcast:15 row_mask:0xf bank_mask:0xf
    v_dot2c_f32_bf16_dpp v15, v31, v123 row_newbcast:15 row_mask:0xf bank_mask:0xf
    v_perm_b32 v152, v157, v153, s77
    v_perm_b32 v157, v157, v153, s61
    s_waitcnt vmcnt(4)
    buffer_load_dwordx4 v[60:63], v2, s[28:31], s56 offen offset:3072 nt
    s_add_u32 s56, s56, 32768
    v_dot2c_f32_bf16_dpp v16, v28, v124 row_newbcast:3 row_mask:0xf bank_mask:0xf
    v_dot2c_f32_bf16_dpp v18, v28, v125 row_newbcast:3 row_mask:0xf bank_mask:0xf
    v_dot2c_f32_bf16_dpp v20, v28, v126 row_newbcast:3 row_mask:0xf bank_mask:0xf
    v_dot2c_f32_bf16_dpp v22, v28, v127 row_newbcast:3 row_mask:0xf bank_mask:0xf
    v_dot2c_f32_bf16_dpp v17, v29, v124 row_newbcast:3 row_mask:0xf bank_mask:0xf
    v_dot2c_f32_bf16_dpp v19, v29, v125 row_newbcast:3 row_mask:0xf bank_mask:0xf
    v_dot2c_f32_bf16_dpp v21, v29, v126 row_newbcast:3 row_mask:0xf bank_mask:0xf
    v_dot2c_f32_bf16_dpp v23, v29, v127 row_newbcast:3 row_mask:0xf bank_mask:0xf
    v_perm_b32 v153, v158, v154, s77
    v_perm_b32 v158, v158, v154, s61
    s_cmp_lg_u32 s3, 0
    s_cbranch_scc1 L_flagok
    v_readfirstlane_b32 s74, v32
    s_cmp_lg_u32 s74, 0
    s_cbranch_scc1 L_flagok
    s_mov_b32 s75, 0x400000
L_spin:
    s_sub_u32 s75, s75, 1
    s_cbranch_scc1 L_flagok
    v_mov_b32 v46, 4
    buffer_load_dword v32, v46, s[44:47], s70 offen sc1
    s_waitcnt vmcnt(0)
    v_readfirstlane_b32 s74, v32
    s_cmp_lg_u32 s74, 0
    s_cbranch_scc0 L_spin
L_flagok:
    s_barrier
    s_waitcnt lgkmcnt(0)
    ds_read_b32 v30, v5
    ds_read_b32 v28, v6
    v_add_u32 v5, 256, v5
    v_add_u32 v6, 64, v6
    v_and_or_b32 v6, v6, s95, v1
    s_waitcnt lgkmcnt(0)
    v_lshlrev_b32 v31, 16, v30
    v_lshlrev_b32 v29, 16, v28
    s_waitcnt vmcnt(4)
    buffer_load_dwordx4 v[64:67], v3, s[32:35], s57 offen
    s_add_u32 s57, s57, s58
    s_cmp_ge_u32 s57, s76
    s_cselect_b32 s57, 0, s57
    v_dot2c_f32_bf16_dpp v8, v30, v48 row_newbcast:0 row_mask:0xf bank_mask:0xf
    v_dot2c_f32_bf16_dpp v10, v30, v49 row_newbcast:0 row_mask:0xf bank_mask:0xf
    v_dot2c_f32_bf16_dpp v12, v30, v50 row_newbcast:0 row_mask:0xf bank_mask:0xf
    v_dot2c_f32_bf16_dpp v14, v30, v51 row_newbcast:0 row_mask:0xf bank_mask:0xf
    v_dot2c_f32_bf16_dpp v9, v31, v48 row_newbcast:0 row_mask:0xf bank_mask:0xf
    v_dot2c_f32_bf16_dpp v11, v31, v49 row_newbcast:0 row_mask:0xf bank_mask:0xf
    v_dot2c_f32_bf16_dpp v13, v31, v50 row_newbcast:0 row_mask:0xf bank_mask:0xf
    v_dot2c_f32_bf16_dpp v15, v31, v51 row_newbcast:0 row_mask:0xf bank_mask:0xf
    v_perm_b32 v154, v159, v155, s77
    v_perm_b32 v159, v159, v155, s61
    s_waitcnt vmcnt(3)
    buffer_load_dwordx4 v[164:167], v4, s[36:39], s60 offen
    s_add_u32 s60, s60, 8192
    s_and_b32 s60, s60, 262143
    v_dot2c_f32_bf16_dpp v8, v30, v52 row_newbcast:1 row_mask:0xf bank_mask:0xf
    v_dot2c_f32_bf16_dpp v10, v30, v53 row_newbcast:1 row_mask:0xf bank_mask:0xf
    v_dot2c_f32_bf16_dpp v12, v30, v54 row_newbcast:1 row_mask:0xf bank_mask:0xf
    v_dot2c_f32_bf16_dpp v14, v30, v55 row_newbcast:1 row_mask:0xf bank_mask:0xf
    v_dot2c_f32_bf16_dpp v9, v31, v52 row_newbcast:1 row_mask:0xf bank_mask:0xf
    v_dot2c_f32_bf16_dpp v11, v31, v53 row_newbcast:1 row_mask:0xf bank_mask:0xf
    v_dot2c_f32_bf16_dpp v13, v31, v54 row_newbcast:1 row_mask:0xf bank_mask:0xf
    v_dot2c_f32_bf16_dpp v15, v31, v55 row_newbcast:1 row_mask:0xf bank_mask:0xf
    s_waitcnt vmcnt(3)
    buffer_load_dwordx4 v[68:71], v2, s[28:31], s56 offen nt
    buffer_load_dwordx4 v[72:75], v2, s[28:31], s56 offen offset:1024 nt
    v_dot2c_f32_bf16_dpp v8, v30, v56 row_newbcast:2 row_mask:0xf bank_mask:0xf
    v_dot2c_f32_bf16_dpp v10, v30, v57 row_newbcast:2 row_mask:0xf bank_mask:0xf
    v_dot2c_f32_bf16_dpp v12, v30, v58 row_newbcast:2 row_mask:0xf bank_mask:0xf
    v_dot2c_f32_bf16_dpp v14, v30, v59 row_newbcast:2 row_mask:0xf bank_mask:0xf
    v_dot2c_f32_bf16_dpp v9, v31, v56 row_newbcast:2 row_mask:0xf bank_mask:0xf
    v_dot2c_f32_bf16_dpp v11, v31, v57 row_newbcast:2 row_mask:0xf bank_mask:0xf
    v_dot2c_f32_bf16_dpp v13, v31, v58 row_newbcast:2 row_mask:0xf bank_mask:0xf
    v_dot2c_f32_bf16_dpp v15, v31, v59 row_newbcast:2 row_mask:0xf bank_mask:0xf
    s_waitcnt vmcnt(4)
    v_dot2c_f32_bf16_dpp v8, v30, v60 row_newbcast:3 row_mask:0xf bank_mask:0xf
    v_dot2c_f32_bf16_dpp v10, v30, v61 row_newbcast:3 row_mask:0xf bank_mask:0xf
    v_dot2c_f32_bf16_dpp v12, v30, v62 row_newbcast:3 row_mask:0xf bank_mask:0xf
    v_dot2c_f32_bf16_dpp v14, v30, v63 row_newbcast:3 row_mask:0xf bank_mask:0xf
    v_dot2c_f32_bf16_dpp v9, v31, v60 row_newbcast:3 row_mask:0xf bank_mask:0xf
    v_dot2c_f32_bf16_dpp v11, v31, v61 row_newbcast:3 row_mask:0xf bank_mask:0xf
    v_dot2c_f32_bf16_dpp v13, v31, v62 row_newbcast:3 row_mask:0xf bank_mask:0xf
    v_dot2c_f32_bf16_dpp v15, v31, v63 row_newbcast:3 row_mask:0xf bank_mask:0xf
    s_waitcnt vmcnt(3)
    buffer_load_dwordx4 v[76:79], v2, s[28:31], s56 offen offset:2048 nt
    buffer_load_dwordx4 v[80:83], v2, s[28:31], s56 offen offset:3072 nt
    s_add_u32 s56, s56, 32768
    v_dot2c_f32_bf16_dpp v16, v28, v64 row_newbcast:0 row_mask:0xf bank_mask:0xf
    v_dot2c_f32_bf16_dpp v18, v28, v65 row_newbcast:0 row_mask:0xf bank_mask:0xf
    v_dot2c_f32_bf16_dpp v20, v28, v66 row_newbcast:0 row_mask:0xf bank_mask:0xf
    v_dot2c_f32_bf16_dpp v22, v28, v67 row_newbcast:0 row_mask:0xf bank_mask:0xf
    v_dot2c_f32_bf16_dpp v17, v29, v64 row_newbcast:0 row_mask:0xf bank_mask:0xf
    v_dot2c_f32_bf16_dpp v19, v29, v65 row_newbcast:0 row_mask:0xf bank_mask:0xf
    v_dot2c_f32_bf16_dpp v21, v29, v66 row_newbcast:0 row_mask:0xf bank_mask:0xf
    v_dot2c_f32_bf16_dpp v23, v29, v67 row_newbcast:0 row_mask:0xf bank_mask:0xf
    s_waitcnt vmcnt(3)
    buffer_load_dwordx4 v[168:171], v4, s[36:39], s60 offen
    s_add_u32 s60, s60, 8192
    s_and_b32 s60, s60, 262143
    v_dot2c_f32_bf16_dpp v8, v30, v68 row_newbcast:4 row_mask:0xf bank_mask:0xf
    v_dot2c_f32_bf16_dpp v10, v30, v69 row_newbcast:4 row_mask:0xf bank_mask:0xf
    v_dot2c_f32_bf16_dpp v12, v30, v70 row_newbcast:4 row_mask:0xf bank_mask:0xf
    v_dot2c_f32_bf16_dpp v14, v30, v71 row_newbcast:4 row_mask:0xf bank_mask:0xf
    v_dot2c_f32_bf16_dpp v9, v31, v68 row_newbcast:4 row_mask:0xf bank_mask:0xf
    v_dot2c_f32_bf16_dpp v11, v31, v69 row_newbcast:4 row_mask:0xf bank_mask:0xf
    v_dot2c_f32_bf16_dpp v13, v31, v70 row_newbcast:4 row_mask:0xf bank_mask:0xf
    v_dot2c_f32_bf16_dpp v15, v31, v71 row_newbcast:4 row_mask:0xf bank_mask:0xf
    v_perm_b32 v155, v164, v160, s77
    v_perm_b32 v164, v164, v160, s61
    s_waitcnt vmcnt(3)
    buffer_load_dwordx4 v[84:87], v3, s[32:35], s57 offen
    s_add_u32 s57, s57, s58
    s_cmp_ge_u32 s57, s76
    s_cselect_b32 s57, 0, s57
    buffer_load_dwordx4 v[88:91], v2, s[28:31], s56 offen nt
    v_dot2c_f32_bf16_dpp v8, v30, v72 row_newbcast:5 row_mask:0xf bank_mask:0xf
    v_dot2c_f32_bf16_dpp v10, v30, v73 row_newbcast:5 row_mask:0xf bank_mask:0xf
    v_dot2c_f32_bf16_dpp v12, v30, v74 row_newbcast:5 row_mask:0xf bank_mask:0xf
    v_dot2c_f32_bf16_dpp v14, v30, v75 row_newbcast:5 row_mask:0xf bank_mask:0xf
    v_dot2c_f32_bf16_dpp v9, v31, v72 row_newbcast:5 row_mask:0xf bank_mask:0xf
    v_dot2c_f32_bf16_dpp v11, v31, v73 row_newbcast:5 row_mask:0xf bank_mask:0xf
    v_dot2c_f32_bf16_dpp v13, v31, v74 row_newbcast:5 row_mask:0xf bank_mask:0xf
    v_dot2c_f32_bf16_dpp v15, v31, v75 row_newbcast:5 row_mask:0xf bank_mask:0xf
    v_perm_b32 v160, v165, v161, s77
    v_perm_b32 v165, v165, v161, s61
    s_waitcnt vmcnt(4)
    v_dot2c_f32_bf16_dpp v8, v30, v76 row_newbcast:6 row_mask:0xf bank_mask:0xf
    v_dot2c_f32_bf16_dpp v10, v30, v77 row_newbcast:6 row_mask:0xf bank_mask:0xf
    v_dot2c_f32_bf16_dpp v12, v30, v78 row_newbcast:6 row_mask:0xf bank_mask:0xf
    v_dot2c_f32_bf16_dpp v14, v30, v79 row_newbcast:6 row_mask:0xf bank_mask:0xf
    v_dot2c_f32_bf16_dpp v9, v31, v76 row_newbcast:6 row_mask:0xf bank_mask:0xf
    v_dot2c_f32_bf16_dpp v11, v31, v77 row_newbcast:6 row_mask:0xf bank_mask:0xf
    v_dot2c_f32_bf16_dpp v13, v31, v78 row_newbcast:6 row_mask:0xf bank_mask:0xf
    v_dot2c_f32_bf16_dpp v15, v31, v79 row_newbcast:6 row_mask:0xf bank_mask:0xf
    v_perm_b32 v161, v166, v162, s77
    v_perm_b32 v166, v166, v162, s61
    s_waitcnt vmcnt(3)
    buffer_load_dwordx4 v[92:95], v2, s[28:31], s56 offen offset:1024 nt
    buffer_load_dwordx4 v[96:99], v2, s[28:31], s56 offen offset:2048 nt
    v_dot2c_f32_bf16_dpp v8, v30, v80 row_newbcast:7 row_mask:0xf bank_mask:0xf
    v_dot2c_f32_bf16_dpp v10, v30, v81 row_newbcast:7 row_mask:0xf bank_mask:0xf
    v_dot2c_f32_bf16_dpp v12, v30, v82 row_newbcast:7 row_mask:0xf bank_mask:0xf
    v_dot2c_f32_bf16_dpp v14, v30, v83 row_newbcast:7 row_mask:0xf bank_mask:0xf
    v_dot2c_f32_bf16_dpp v9, v31, v80 row_newbcast:7 row_mask:0xf bank_mask:0xf
    v_dot2c_f32_bf16_dpp v11, v31, v81 row_newbcast:7 row_mask:0xf bank_mask:0xf
    v_dot2c_f32_bf16_dpp v13, v31, v82 row_newbcast:7 row_mask:0xf bank_mask:0xf
    v_dot2c_f32_bf16_dpp v15, v31, v83 row_newbcast:7 row_mask:0xf bank_mask:0xf
    v_perm_b32 v162, v167, v163, s77
    v_perm_b32 v167, v167, v163, s61
    s_waitcnt vmcnt(3)
    buffer_load_dwordx4 v[172:175], v4, s[36:39], s60 offen
    s_add_u32 s60, s60, 8192
    s_and_b32 s60, s60, 262143
    v_dot2c_f32_bf16_dpp v16, v28, v84 row_newbcast:1 row_mask:0xf bank_mask:0xf
    v_dot2c_f32_bf16_dpp v18, v28, v85 row_newbcast:1 row_mask:0xf bank_mask:0xf
    v_dot2c_f32_bf16_dpp v20, v28, v86 row_newbcast:1 row_mask:0xf bank_mask:0xf
    v_dot2c_f32_bf16_dpp v22, v28, v87 row_newbcast:1 row_mask:0xf bank_mask:0xf
    v_dot2c_f32_bf16_dpp v17, v29, v84 row_newbcast:1 row_mask:0xf bank_mask:0xf
    v_dot2c_f32_bf16_dpp v19, v29, v85 row_newbcast:1 row_mask:0xf bank_mask:0xf
    v_dot2c_f32_bf16_dpp v21, v29, v86 row_newbcast:1 row_mask:0xf bank_mask:0xf
    v_dot2c_f32_bf16_dpp v23, v29, v87 row_newbcast:1 row_mask:0xf bank_mask:0xf
    s_waitcnt vmcnt(3)
    buffer_load_dwordx4 v[100:103], v2, s[28:31], s56 offen offset:3072 nt
    s_add_u32 s56, s56, 32768
    buffer_load_dwordx4 v[104:107], v3, s[32:35], s57 offen
    s_add_u32 s57, s57, s58
    s_cmp_ge_u32 s57, s76
    s_cselect_b32 s57, 0, s57
    v_dot2c_f32_bf16_dpp v8, v30, v88 row_newbcast:8 row_mask:0xf bank_mask:0xf
    v_dot2c_f32_bf16_dpp v10, v30, v89 row_newbcast:8 row_mask:0xf bank_mask:0xf
    v_dot2c_f32_bf16_dpp v12, v30, v90 row_newbcast:8 row_mask:0xf bank_mask:0xf
    v_dot2c_f32_bf16_dpp v14, v30, v91 row_newbcast:8 row_mask:0xf bank_mask:0xf
    v_dot2c_f32_bf16_dpp v9, v31, v88 row_newbcast:8 row_mask:0xf bank_mask:0xf
    v_dot2c_f32_bf16_dpp v11, v31, v89 row_newbcast:8 row_mask:0xf bank_mask:0xf
    v_dot2c_f32_bf16_dpp v13, v31, v90 row_newbcast:8 row_mask:0xf bank_mask:0xf
    v_dot2c_f32_bf16_dpp v15, v31, v91 row_newbcast:8 row_mask:0xf bank_mask:0xf
    s_waitcnt vmcnt(4)
    v_dot2c_f32_bf16_dpp v8, v30, v92 row_newbcast:9 row_mask:0xf bank_mask:0xf
    v_dot2c_f32_bf16_dpp v10, v30, v93 row_newbcast:9 row_mask:0xf bank_mask:0xf
    v_dot2c_f32_bf16_dpp v12, v30, v94 row_newbcast:9 row_mask:0xf bank_mask:0xf
    v_dot2c_f32_bf16_dpp v14, v30, v95 row_newbcast:9 row_mask:0xf bank_mask:0xf
    v_dot2c_f32_bf16_dpp v9, v31, v92 row_newbcast:9 row_mask:0xf bank_mask:0xf
    v_dot2c_f32_bf16_dpp v11, v31, v93 row_newbcast:9 row_mask:0xf bank_mask:0xf
    v_dot2c_f32_bf16_dpp v13, v31, v94 row_newbcast:9 row_mask:0xf bank_mask:0xf
    v_dot2c_f32_bf16_dpp v15, v31, v95 row_newbcast:9 row_mask:0xf bank_mask:0xf
    s_waitcnt vmcnt(3)
    buffer_load_dwordx4 v[108:111], v2, s[28:31], s56 offen nt
    buffer_load_dwordx4 v[112:115], v2, s[28:31], s56 offen offset:1024 nt
    v_dot2c_f32_bf16_dpp v8, v30, v96 row_newbcast:10 row_mask:0xf bank_mask:0xf
    v_dot2c_f32_bf16_dpp v10, v30, v97 row_newbcast:10 row_mask:0xf bank_mask:0xf
    v_dot2c_f32_bf16_dpp v12, v30, v98 row_newbcast:10 row_mask:0xf bank_mask:0xf
    v_dot2c_f32_bf16_dpp v14, v30, v99 row_newbcast:10 row_mask:0xf bank_mask:0xf
    v_dot2c_f32_bf16_dpp v9, v31, v96 row_newbcast:10 row_mask:0xf bank_mask:0xf
    v_dot2c_f32_bf16_dpp v11, v31, v97 row_newbcast:10 row_mask:0xf bank_mask:0xf
    v_dot2c_f32_bf16_dpp v13, v31, v98 row_newbcast:10 row_mask:0xf bank_mask:0xf
    v_dot2c_f32_bf16_dpp v15, v31, v99 row_newbcast:10 row_mask:0xf bank_mask:0xf
    s_waitcnt vmcnt(3)
    buffer_load_dwordx4 v[176:179], v4, s[36:39], s60 offen
    s_add_u32 s60, s60, 8192
    s_and_b32 s60, s60, 262143
    v_dot2c_f32_bf16_dpp v8, v30, v100 row_newbcast:11 row_mask:0xf bank_mask:0xf
    v_dot2c_f32_bf16_dpp v10, v30, v101 row_newbcast:11 row_mask:0xf bank_mask:0xf
    v_dot2c_f32_bf16_dpp v12, v30, v102 row_newbcast:11 row_mask:0xf bank_mask:0xf
    v_dot2c_f32_bf16_dpp v14, v30, v103 row_newbcast:11 row_mask:0xf bank_mask:0xf
    v_dot2c_f32_bf16_dpp v9, v31, v100 row_newbcast:11 row_mask:0xf bank_mask:0xf
    v_dot2c_f32_bf16_dpp v11, v31, v101 row_newbcast:11 row_mask:0xf bank_mask:0xf
    v_dot2c_f32_bf16_dpp v13, v31, v102 row_newbcast:11 row_mask:0xf bank_mask:0xf
    v_dot2c_f32_bf16_dpp v15, v31, v103 row_newbcast:11 row_mask:0xf bank_mask:0xf
    v_perm_b32 v163, v172, v168, s77
    v_perm_b32 v172, v172, v168, s61
    s_waitcnt vmcnt(3)
    buffer_load_dwordx4 v[116:119], v2, s[28:31], s56 offen offset:2048 nt
    buffer_load_dwordx4 v[120:123], v2, s[28:31], s56 offen offset:3072 nt
    s_add_u32 s56, s56, 32768
    v_dot2c_f32_bf16_dpp v16, v28, v104 row_newbcast:2 row_mask:0xf bank_mask:0xf
    v_dot2c_f32_bf16_dpp v18, v28, v105 row_newbcast:2 row_mask:0xf bank_mask:0xf
    v_dot2c_f32_bf16_dpp v20, v28, v106 row_newbcast:2 row_mask:0xf bank_mask:0xf
    v_dot2c_f32_bf16_dpp v22, v28, v107 row_newbcast:2 row_mask:0xf bank_mask:0xf
    v_dot2c_f32_bf16_dpp v17, v29, v104 row_newbcast:2 row_mask:0xf bank_mask:0xf
    v_dot2c_f32_bf16_dpp v19, v29, v105 row_newbcast:2 row_mask:0xf bank_mask:0xf
    v_dot2c_f32_bf16_dpp v21, v29, v106 row_newbcast:2 row_mask:0xf bank_mask:0xf
    v_dot2c_f32_bf16_dpp v23, v29, v107 row_newbcast:2 row_mask:0xf bank_mask:0xf
    v_perm_b32 v168, v173, v169, s77
    v_perm_b32 v173, v173, v169, s61
    s_waitcnt vmcnt(4)
    v_dot2c_f32_bf16_dpp v8, v30, v108 row_newbcast:12 row_mask:0xf bank_mask:0xf
    v_dot2c_f32_bf16_dpp v10, v30, v109 row_newbcast:12 row_mask:0xf bank_mask:0xf
    v_dot2c_f32_bf16_dpp v12, v30, v110 row_newbcast:12 row_mask:0xf bank_mask:0xf
    v_dot2c_f32_bf16_dpp v14, v30, v111 row_newbcast:12 row_mask:0xf bank_mask:0xf
    v_dot2c_f32_bf16_dpp v9, v31, v108 row_newbcast:12 row_mask:0xf bank_mask:0xf
    v_dot2c_f32_bf16_dpp v11, v31, v109 row_newbcast:12 row_mask:0xf bank_mask:0xf
    v_dot2c_f32_bf16_dpp v13, v31, v110 row_newbcast:12 row_mask:0xf bank_mask:0xf
    v_dot2c_f32_bf16_dpp v15, v31, v111 row_newbcast:12 row_mask:0xf bank_mask:0xf
    v_perm_b32 v169, v174, v170, s77
    v_perm_b32 v174, v174, v170, s61
    s_waitcnt vmcnt(3)
    buffer_load_dwordx4 v[124:127], v3, s[32:35], s57 offen
    s_add_u32 s57, s57, s58
    s_cmp_ge_u32 s57, s76
    s_cselect_b32 s57, 0, s57
    buffer_load_dwordx4 v[48:51], v2, s[28:31], s56 offen nt
    v_dot2c_f32_bf16_dpp v8, v30, v112 row_newbcast:13 row_mask:0xf bank_mask:0xf
    v_dot2c_f32_bf16_dpp v10, v30, v113 row_newbcast:13 row_mask:0xf bank_mask:0xf
    v_dot2c_f32_bf16_dpp v12, v30, v114 row_newbcast:13 row_mask:0xf bank_mask:0xf
    v_dot2c_f32_bf16_dpp v14, v30, v115 row_newbcast:13 row_mask:0xf bank_mask:0xf
    v_dot2c_f32_bf16_dpp v9, v31, v112 row_newbcast:13 row_mask:0xf bank_mask:0xf
    v_dot2c_f32_bf16_dpp v11, v31, v113 row_newbcast:13 row_mask:0xf bank_mask:0xf
    v_dot2c_f32_bf16_dpp v13, v31, v114 row_newbcast:13 row_mask:0xf bank_mask:0xf
    v_dot2c_f32_bf16_dpp v15, v31, v115 row_newbcast:13 row_mask:0xf bank_mask:0xf
    v_perm_b32 v170, v175, v171, s77
    v_perm_b32 v175, v175, v171, s61
    s_waitcnt vmcnt(3)
    buffer_load_dwordx4 v[180:183], v4, s[36:39], s60 offen
    s_add_u32 s60, s60, 8192
    s_and_b32 s60, s60, 262143
    v_dot2c_f32_bf16_dpp v8, v30, v116 row_newbcast:14 row_mask:0xf bank_mask:0xf
    v_dot2c_f32_bf16_dpp v10, v30, v117 row_newbcast:14 row_mask:0xf bank_mask:0xf
    v_dot2c_f32_bf16_dpp v12, v30, v118 row_newbcast:14 row_mask:0xf bank_mask:0xf
    v_dot2c_f32_bf16_dpp v14, v30, v119 row_newbcast:14 row_mask:0xf bank_mask:0xf
    v_dot2c_f32_bf16_dpp v9, v31, v116 row_newbcast:14 row_mask:0xf bank_mask:0xf
    v_dot2c_f32_bf16_dpp v11, v31, v117 row_newbcast:14 row_mask:0xf bank_mask:0xf
    v_dot2c_f32_bf16_dpp v13, v31, v118 row_newbcast:14 row_mask:0xf bank_mask:0xf
    v_dot2c_f32_bf16_dpp v15, v31, v119 row_newbcast:14 row_mask:0xf bank_mask:0xf
    s_waitcnt vmcnt(3)
    buffer_load_dwordx4 v[52:55], v2, s[28:31], s56 offen offset:1024 nt
    buffer_load_dwordx4 v[56:59], v2, s[28:31], s56 offen offset:2048 nt
    v_dot2c_f32_bf16_dpp v8, v30, v120 row_newbcast:15 row_mask:0xf bank_mask:0xf
    v_dot2c_f32_bf16_dpp v10, v30, v121 row_newbcast:15 row_mask:0xf bank_mask:0xf
    v_dot2c_f32_bf16_dpp v12, v30, v122 row_newbcast:15 row_mask:0xf bank_mask:0xf
    v_dot2c_f32_bf16_dpp v14, v30, v123 row_newbcast:15 row_mask:0xf bank_mask:0xf
    v_dot2c_f32_bf16_dpp v9, v31, v120 row_newbcast:15 row_mask:0xf bank_mask:0xf
    v_dot2c_f32_bf16_dpp v11, v31, v121 row_newbcast:15 row_mask:0xf bank_mask:0xf
    v_dot2c_f32_bf16_dpp v13, v31, v122 row_newbcast:15 row_mask:0xf bank_mask:0xf
    v_dot2c_f32_bf16_dpp v15, v31, v123 row_newbcast:15 row_mask:0xf bank_mask:0xf
    s_waitcnt vmcnt(4)
    buffer_load_dwordx4 v[60:63], v2, s[28:31], s56 offen offset:3072 nt
    s_add_u32 s56, s56, 32768
    v_dot2c_f32_bf16_dpp v16, v28, v124 row_newbcast:3 row_mask:0xf bank_mask:0xf
    v_dot2c_f32_bf16_dpp v18, v28, v125 row_newbcast:3 row_mask:0xf bank_mask:0xf
    v_dot2c_f32_bf16_dpp v20, v28, v126 row_newbcast:3 row_mask:0xf bank_mask:0xf
    v_dot2c_f32_bf16_dpp v22, v28, v127 row_newbcast:3 row_mask:0xf bank_mask:0xf
    v_dot2c_f32_bf16_dpp v17, v29, v124 row_newbcast:3 row_mask:0xf bank_mask:0xf
    v_dot2c_f32_bf16_dpp v19, v29, v125 row_newbcast:3 row_mask:0xf bank_mask:0xf
    v_dot2c_f32_bf16_dpp v21, v29, v126 row_newbcast:3 row_mask:0xf bank_mask:0xf
    v_dot2c_f32_bf16_dpp v23, v29, v127 row_newbcast:3 row_mask:0xf bank_mask:0xf
    s_barrier
    s_waitcnt lgkmcnt(0)
    ds_read_b32 v30, v5
    ds_read_b32 v28, v6
    v_add_u32 v5, 256, v5
    v_add_u32 v6, 64, v6
    v_and_or_b32 v6, v6, s95, v1
    s_waitcnt lgkmcnt(0)
    v_lshlrev_b32 v31, 16, v30
    v_lshlrev_b32 v29, 16, v28
    s_waitcnt vmcnt(4)
    buffer_load_dwordx4 v[64:67], v3, s[32:35], s57 offen
    s_add_u32 s57, s57, s58
    s_cmp_ge_u32 s57, s76
    s_cselect_b32 s57, 0, s57
    v_dot2c_f32_bf16_dpp v8, v30, v48 row_newbcast:0 row_mask:0xf bank_mask:0xf
    v_dot2c_f32_bf16_dpp v10, v30, v49 row_newbcast:0 row_mask:0xf bank_mask:0xf
    v_dot2c_f32_bf16_dpp v12, v30, v50 row_newbcast:0 row_mask:0xf bank_mask:0xf
    v_dot2c_f32_bf16_dpp v14, v30, v51 row_newbcast:0 row_mask:0xf bank_mask:0xf
    v_dot2c_f32_bf16_dpp v9, v31, v48 row_newbcast:0 row_mask:0xf bank_mask:0xf
    v_dot2c_f32_bf16_dpp v11, v31, v49 row_newbcast:0 row_mask:0xf bank_mask:0xf
    v_dot2c_f32_bf16_dpp v13, v31, v50 row_newbcast:0 row_mask:0xf bank_mask:0xf
    v_dot2c_f32_bf16_dpp v15, v31, v51 row_newbcast:0 row_mask:0xf bank_mask:0xf
    s_waitcnt vmcnt(3)
    buffer_load_dwordx4 v[184:187], v4, s[36:39], s60 offen
    s_add_u32 s60, s60, 8192
    s_and_b32 s60, s60, 262143
    v_dot2c_f32_bf16_dpp v8, v30, v52 row_newbcast:1 row_mask:0xf bank_mask:0xf
    v_dot2c_f32_bf16_dpp v10, v30, v53 row_newbcast:1 row_mask:0xf bank_mask:0xf
    v_dot2c_f32_bf16_dpp v12, v30, v54 row_newbcast:1 row_mask:0xf bank_mask:0xf
    v_dot2c_f32_bf16_dpp v14, v30, v55 row_newbcast:1 row_mask:0xf bank_mask:0xf
    v_dot2c_f32_bf16_dpp v9, v31, v52 row_newbcast:1 row_mask:0xf bank_mask:0xf
    v_dot2c_f32_bf16_dpp v11, v31, v53 row_newbcast:1 row_mask:0xf bank_mask:0xf
    v_dot2c_f32_bf16_dpp v13, v31, v54 row_newbcast:1 row_mask:0xf bank_mask:0xf
    v_dot2c_f32_bf16_dpp v15, v31, v55 row_newbcast:1 row_mask:0xf bank_mask:0xf
    v_perm_b32 v171, v180, v176, s77
    v_perm_b32 v180, v180, v176, s61
    s_waitcnt vmcnt(3)
    buffer_load_dwordx4 v[68:71], v2, s[28:31], s56 offen nt
    buffer_load_dwordx4 v[72:75], v2, s[28:31], s56 offen offset:1024 nt
    v_dot2c_f32_bf16_dpp v8, v30, v56 row_newbcast:2 row_mask:0xf bank_mask:0xf
    v_dot2c_f32_bf16_dpp v10, v30, v57 row_newbcast:2 row_mask:0xf bank_mask:0xf
    v_dot2c_f32_bf16_dpp v12, v30, v58 row_newbcast:2 row_mask:0xf bank_mask:0xf
    v_dot2c_f32_bf16_dpp v14, v30, v59 row_newbcast:2 row_mask:0xf bank_mask:0xf
    v_dot2c_f32_bf16_dpp v9, v31, v56 row_newbcast:2 row_mask:0xf bank_mask:0xf
    v_dot2c_f32_bf16_dpp v11, v31, v57 row_newbcast:2 row_mask:0xf bank_mask:0xf
    v_dot2c_f32_bf16_dpp v13, v31, v58 row_newbcast:2 row_mask:0xf bank_mask:0xf
    v_dot2c_f32_bf16_dpp v15, v31, v59 row_newbcast:2 row_mask:0xf bank_mask:0xf
    v_perm_b32 v176, v181, v177, s77
    v_perm_b32 v181, v181, v177, s61
    s_waitcnt vmcnt(4)
    v_dot2c_f32_bf16_dpp v8, v30, v60 row_newbcast:3 row_mask:0xf bank_mask:0xf
    v_dot2c_f32_bf16_dpp v10, v30, v61 row_newbcast:3 row_mask:0xf bank_mask:0xf
    v_dot2c_f32_bf16_dpp v12, v30, v62 row_newbcast:3 row_mask:0xf bank_mask:0xf
    v_dot2c_f32_bf16_dpp v14, v30, v63 row_newbcast:3 row_mask:0xf bank_mask:0xf
    v_dot2c_f32_bf16_dpp v9, v31, v60 row_newbcast:3 row_mask:0xf bank_mask:0xf
    v_dot2c_f32_bf16_dpp v11, v31, v61 row_newbcast:3 row_mask:0xf bank_mask:0xf
    v_dot2c_f32_bf16_dpp v13, v31, v62 row_newbcast:3 row_mask:0xf bank_mask:0xf
    v_dot2c_f32_bf16_dpp v15, v31, v63 row_newbcast:3 row_mask:0xf bank_mask:0xf
    v_perm_b32 v177, v182, v178, s77
    v_perm_b32 v182, v182, v178, s61
    s_waitcnt vmcnt(3)
    buffer_load_dwordx4 v[76:79], v2, s[28:31], s56 offen offset:2048 nt
    buffer_load_dwordx4 v[80:83], v2, s[28:31], s56 offen offset:3072 nt
    s_add_u32 s56, s56, 32768
    v_dot2c_f32_bf16_dpp v16, v28, v64 row_newbcast:0 row_mask:0xf bank_mask:0xf
    v_dot2c_f32_bf16_dpp v18, v28, v65 row_newbcast:0 row_mask:0xf bank_mask:0xf
    v_dot2c_f32_bf16_dpp v20, v28, v66 row_newbcast:0 row_mask:0xf bank_mask:0xf
    v_dot2c_f32_bf16_dpp v22, v28, v67 row_newbcast:0 row_mask:0xf bank_mask:0xf
    v_dot2c_f32_bf16_dpp v17, v29, v64 row_newbcast:0 row_mask:0xf bank_mask:0xf
    v_dot2c_f32_bf16_dpp v19, v29, v65 row_newbcast:0 row_mask:0xf bank_mask:0xf
    v_dot2c_f32_bf16_dpp v21, v29, v66 row_newbcast:0 row_mask:0xf bank_mask:0xf
    v_dot2c_f32_bf16_dpp v23, v29, v67 row_newbcast:0 row_mask:0xf bank_mask:0xf
    v_perm_b32 v178, v183, v179, s77
    v_perm_b32 v183, v183, v179, s61
    s_waitcnt vmcnt(3)
    buffer_load_dwordx4 v[188:191], v4, s[36:39], s60 offen
    s_add_u32 s60, s60, 8192
    s_and_b32 s60, s60, 262143
    v_dot2c_f32_bf16_dpp v8, v30, v68 row_newbcast:4 row_mask:0xf bank_mask:0xf
    v_dot2c_f32_bf16_dpp v10, v30, v69 row_newbcast:4 row_mask:0xf bank_mask:0xf
    v_dot2c_f32_bf16_dpp v12, v30, v70 row_newbcast:4 row_mask:0xf bank_mask:0xf
    v_dot2c_f32_bf16_dpp v14, v30, v71 row_newbcast:4 row_mask:0xf bank_mask:0xf
    v_dot2c_f32_bf16_dpp v9, v31, v68 row_newbcast:4 row_mask:0xf bank_mask:0xf
    v_dot2c_f32_bf16_dpp v11, v31, v69 row_newbcast:4 row_mask:0xf bank_mask:0xf
    v_dot2c_f32_bf16_dpp v13, v31, v70 row_newbcast:4 row_mask:0xf bank_mask:0xf
    v_dot2c_f32_bf16_dpp v15, v31, v71 row_newbcast:4 row_mask:0xf bank_mask:0xf
    s_waitcnt vmcnt(3)
    buffer_load_dwordx4 v[84:87], v3, s[32:35], s57 offen
    s_add_u32 s57, s57, s58
    s_cmp_ge_u32 s57, s76
    s_cselect_b32 s57, 0, s57
    buffer_load_dwordx4 v[88:91], v2, s[28:31], s56 offen nt
    v_dot2c_f32_bf16_dpp v8, v30, v72 row_newbcast:5 row_mask:0xf bank_mask:0xf
    v_dot2c_f32_bf16_dpp v10, v30, v73 row_newbcast:5 row_mask:0xf bank_mask:0xf
    v_dot2c_f32_bf16_dpp v12, v30, v74 row_newbcast:5 row_mask:0xf bank_mask:0xf
    v_dot2c_f32_bf16_dpp v14, v30, v75 row_newbcast:5 row_mask:0xf bank_mask:0xf
    v_dot2c_f32_bf16_dpp v9, v31, v72 row_newbcast:5 row_mask:0xf bank_mask:0xf
    v_dot2c_f32_bf16_dpp v11, v31, v73 row_newbcast:5 row_mask:0xf bank_mask:0xf
    v_dot2c_f32_bf16_dpp v13, v31, v74 row_newbcast:5 row_mask:0xf bank_mask:0xf
    v_dot2c_f32_bf16_dpp v15, v31, v75 row_newbcast:5 row_mask:0xf bank_mask:0xf
    s_waitcnt vmcnt(4)
    v_dot2c_f32_bf16_dpp v8, v30, v76 row_newbcast:6 row_mask:0xf bank_mask:0xf
    v_dot2c_f32_bf16_dpp v10, v30, v77 row_newbcast:6 row_mask:0xf bank_mask:0xf
    v_dot2c_f32_bf16_dpp v12, v30, v78 row_newbcast:6 row_mask:0xf bank_mask:0xf
    v_dot2c_f32_bf16_dpp v14, v30, v79 row_newbcast:6 row_mask:0xf bank_mask:0xf
    v_dot2c_f32_bf16_dpp v9, v31, v76 row_newbcast:6 row_mask:0xf bank_mask:0xf
    v_dot2c_f32_bf16_dpp v11, v31, v77 row_newbcast:6 row_mask:0xf bank_mask:0xf
    v_dot2c_f32_bf16_dpp v13, v31, v78 row_newbcast:6 row_mask:0xf bank_mask:0xf
    v_dot2c_f32_bf16_dpp v15, v31, v79 row_newbcast:6 row_mask:0xf bank_mask:0xf
    s_waitcnt vmcnt(3)
    buffer_load_dwordx4 v[92:95], v2, s[28:31], s56 offen offset:1024 nt
    buffer_load_dwordx4 v[96:99], v2, s[28:31], s56 offen offset:2048 nt
    v_dot2c_f32_bf16_dpp v8, v30, v80 row_newbcast:7 row_mask:0xf bank_mask:0xf
    v_dot2c_f32_bf16_dpp v10, v30, v81 row_newbcast:7 row_mask:0xf bank_mask:0xf
    v_dot2c_f32_bf16_dpp v12, v30, v82 row_newbcast:7 row_mask:0xf bank_mask:0xf
    v_dot2c_f32_bf16_dpp v14, v30, v83 row_newbcast:7 row_mask:0xf bank_mask:0xf
    v_dot2c_f32_bf16_dpp v9, v31, v80 row_newbcast:7 row_mask:0xf bank_mask:0xf
    v_dot2c_f32_bf16_dpp v11, v31, v81 row_newbcast:7 row_mask:0xf bank_mask:0xf
    v_dot2c_f32_bf16_dpp v13, v31, v82 row_newbcast:7 row_mask:0xf bank_mask:0xf
    v_dot2c_f32_bf16_dpp v15, v31, v83 row_newbcast:7 row_mask:0xf bank_mask:0xf
    s_waitcnt vmcnt(3)
    buffer_load_dwordx4 v[192:195], v4, s[36:39], s60 offen
    s_add_u32 s60, s60, 8192
    s_and_b32 s60, s60, 262143
    v_dot2c_f32_bf16_dpp v16, v28, v84 row_newbcast:1 row_mask:0xf bank_mask:0xf
    v_dot2c_f32_bf16_dpp v18, v28, v85 row_newbcast:1 row_mask:0xf bank_mask:0xf
    v_dot2c_f32_bf16_dpp v20, v28, v86 row_newbcast:1 row_mask:0xf bank_mask:0xf
    v_dot2c_f32_bf16_dpp v22, v28, v87 row_newbcast:1 row_mask:0xf bank_mask:0xf
    v_dot2c_f32_bf16_dpp v17, v29, v84 row_newbcast:1 row_mask:0xf bank_mask:0xf
    v_dot2c_f32_bf16_dpp v19, v29, v85 row_newbcast:1 row_mask:0xf bank_mask:0xf
    v_dot2c_f32_bf16_dpp v21, v29, v86 row_newbcast:1 row_mask:0xf bank_mask:0xf
    v_dot2c_f32_bf16_dpp v23, v29, v87 row_newbcast:1 row_mask:0xf bank_mask:0xf
    v_perm_b32 v179, v188, v184, s77
    v_perm_b32 v188, v188, v184, s61
    s_waitcnt vmcnt(3)
    buffer_load_dwordx4 v[100:103], v2, s[28:31], s56 offen offset:3072 nt
    s_add_u32 s56, s56, 32768
    buffer_load_dwordx4 v[104:107], v3, s[32:35], s57 offen
    s_add_u32 s57, s57, s58
    s_cmp_ge_u32 s57, s76
    s_cselect_b32 s57, 0, s57
    v_dot2c_f32_bf16_dpp v8, v30, v88 row_newbcast:8 row_mask:0xf bank_mask:0xf
    v_dot2c_f32_bf16_dpp v10, v30, v89 row_newbcast:8 row_mask:0xf bank_mask:0xf
    v_dot2c_f32_bf16_dpp v12, v30, v90 row_newbcast:8 row_mask:0xf bank_mask:0xf
    v_dot2c_f32_bf16_dpp v14, v30, v91 row_newbcast:8 row_mask:0xf bank_mask:0xf
    v_dot2c_f32_bf16_dpp v9, v31, v88 row_newbcast:8 row_mask:0xf bank_mask:0xf
    v_dot2c_f32_bf16_dpp v11, v31, v89 row_newbcast:8 row_mask:0xf bank_mask:0xf
    v_dot2c_f32_bf16_dpp v13, v31, v90 row_newbcast:8 row_mask:0xf bank_mask:0xf
    v_dot2c_f32_bf16_dpp v15, v31, v91 row_newbcast:8 row_mask:0xf bank_mask:0xf
    v_perm_b32 v184, v189, v185, s77
    v_perm_b32 v189, v189, v185, s61
    s_waitcnt vmcnt(4)
    v_dot2c_f32_bf16_dpp v8, v30, v92 row_newbcast:9 row_mask:0xf bank_mask:0xf
    v_dot2c_f32_bf16_dpp v10, v30, v93 row_newbcast:9 row_mask:0xf bank_mask:0xf
    v_dot2c_f32_bf16_dpp v12, v30, v94 row_newbcast:9 row_mask:0xf bank_mask:0xf
    v_dot2c_f32_bf16_dpp v14, v30, v95 row_newbcast:9 row_mask:0xf bank_mask:0xf
    v_dot2c_f32_bf16_dpp v9, v31, v92 row_newbcast:9 row_mask:0xf bank_mask:0xf
    v_dot2c_f32_bf16_dpp v11, v31, v93 row_newbcast:9 row_mask:0xf bank_mask:0xf
    v_dot2c_f32_bf16_dpp v13, v31, v94 row_newbcast:9 row_mask:0xf bank_mask:0xf
    v_dot2c_f32_bf16_dpp v15, v31, v95 row_newbcast:9 row_mask:0xf bank_mask:0xf
    v_perm_b32 v185, v190, v186, s77
    v_perm_b32 v190, v190, v186, s61
    s_waitcnt vmcnt(3)
    buffer_load_dwordx4 v[108:111], v2, s[28:31], s56 offen nt
    buffer_load_dwordx4 v[112:115], v2, s[28:31], s56 offen offset:1024 nt
    v_dot2c_f32_bf16_dpp v8, v30, v96 row_newbcast:10 row_mask:0xf bank_mask:0xf
    v_dot2c_f32_bf16_dpp v10, v30, v97 row_newbcast:10 row_mask:0xf bank_mask:0xf
    v_dot2c_f32_bf16_dpp v12, v30, v98 row_newbcast:10 row_mask:0xf bank_mask:0xf
    v_dot2c_f32_bf16_dpp v14, v30, v99 row_newbcast:10 row_mask:0xf bank_mask:0xf
    v_dot2c_f32_bf16_dpp v9, v31, v96 row_newbcast:10 row_mask:0xf bank_mask:0xf
    v_dot2c_f32_bf16_dpp v11, v31, v97 row_newbcast:10 row_mask:0xf bank_mask:0xf
    v_dot2c_f32_bf16_dpp v13, v31, v98 row_newbcast:10 row_mask:0xf bank_mask:0xf
    v_dot2c_f32_bf16_dpp v15, v31, v99 row_newbcast:10 row_mask:0xf bank_mask:0xf
    v_perm_b32 v186, v191, v187, s77
    v_perm_b32 v191, v191, v187, s61
    s_waitcnt vmcnt(3)
    buffer_load_dwordx4 v[196:199], v4, s[36:39], s60 offen
    s_add_u32 s60, s60, 8192
    s_and_b32 s60, s60, 262143
    v_dot2c_f32_bf16_dpp v8, v30, v100 row_newbcast:11 row_mask:0xf bank_mask:0xf
    v_dot2c_f32_bf16_dpp v10, v30, v101 row_newbcast:11 row_mask:0xf bank_mask:0xf
    v_dot2c_f32_bf16_dpp v12, v30, v102 row_newbcast:11 row_mask:0xf bank_mask:0xf
    v_dot2c_f32_bf16_dpp v14, v30, v103 row_newbcast:11 row_mask:0xf bank_mask:0xf
    v_dot2c_f32_bf16_dpp v9, v31, v100 row_newbcast:11 row_mask:0xf bank_mask:0xf
    v_dot2c_f32_bf16_dpp v11, v31, v101 row_newbcast:11 row_mask:0xf bank_mask:0xf
    v_dot2c_f32_bf16_dpp v13, v31, v102 row_newbcast:11 row_mask:0xf bank_mask:0xf
    v_dot2c_f32_bf16_dpp v15, v31, v103 row_newbcast:11 row_mask:0xf bank_mask:0xf
    s_waitcnt vmcnt(3)
    buffer_load_dwordx4 v[116:119], v2, s[28:31], s56 offen offset:2048 nt
    buffer_load_dwordx4 v[120:123], v2, s[28:31], s56 offen offset:3072 nt
    s_add_u32 s56, s56, 32768
    v_dot2c_f32_bf16_dpp v16, v28, v104 row_newbcast:2 row_mask:0xf bank_mask:0xf
    v_dot2c_f32_bf16_dpp v18, v28, v105 row_newbcast:2 row_mask:0xf bank_mask:0xf
    v_dot2c_f32_bf16_dpp v20, v28, v106 row_newbcast:2 row_mask:0xf bank_mask:0xf
    v_dot2c_f32_bf16_dpp v22, v28, v107 row_newbcast:2 row_mask:0xf bank_mask:0xf
    v_dot2c_f32_bf16_dpp v17, v29, v104 row_newbcast:2 row_mask:0xf bank_mask:0xf
    v_dot2c_f32_bf16_dpp v19, v29, v105 row_newbcast:2 row_mask:0xf bank_mask:0xf
    v_dot2c_f32_bf16_dpp v21, v29, v106 row_newbcast:2 row_mask:0xf bank_mask:0xf
    v_dot2c_f32_bf16_dpp v23, v29, v107 row_newbcast:2 row_mask:0xf bank_mask:0xf
    s_waitcnt vmcnt(4)
    v_dot2c_f32_bf16_dpp v8, v30, v108 row_newbcast:12 row_mask:0xf bank_mask:0xf
    v_dot2c_f32_bf16_dpp v10, v30, v109 row_newbcast:12 row_mask:0xf bank_mask:0xf
    v_dot2c_f32_bf16_dpp v12, v30, v110 row_newbcast:12 row_mask:0xf bank_mask:0xf
    v_dot2c_f32_bf16_dpp v14, v30, v111 row_newbcast:12 row_mask:0xf bank_mask:0xf
    v_dot2c_f32_bf16_dpp v9, v31, v108 row_newbcast:12 row_mask:0xf bank_mask:0xf
    v_dot2c_f32_bf16_dpp v11, v31, v109 row_newbcast:12 row_mask:0xf bank_mask:0xf
    v_dot2c_f32_bf16_dpp v13, v31, v110 row_newbcast:12 row_mask:0xf bank_mask:0xf
    v_dot2c_f32_bf16_dpp v15, v31, v111 row_newbcast:12 row_mask:0xf bank_mask:0xf
    s_waitcnt vmcnt(3)
    buffer_load_dwordx4 v[124:127], v3, s[32:35], s57 offen
    s_add_u32 s57, s57, s58
    s_cmp_ge_u32 s57, s76
    s_cselect_b32 s57, 0, s57
    buffer_load_dwordx4 v[48:51], v2, s[28:31], s56 offen nt
    v_dot2c_f32_bf16_dpp v8, v30, v112 row_newbcast:13 row_mask:0xf bank_mask:0xf
    v_dot2c_f32_bf16_dpp v10, v30, v113 row_newbcast:13 row_mask:0xf bank_mask:0xf
    v_dot2c_f32_bf16_dpp v12, v30, v114 row_newbcast:13 row_mask:0xf bank_mask:0xf
    v_dot2c_f32_bf16_dpp v14, v30, v115 row_newbcast:13 row_mask:0xf bank_mask:0xf
    v_dot2c_f32_bf16_dpp v9, v31, v112 row_newbcast:13 row_mask:0xf bank_mask:0xf
    v_dot2c_f32_bf16_dpp v11, v31, v113 row_newbcast:13 row_mask:0xf bank_mask:0xf
    v_dot2c_f32_bf16_dpp v13, v31, v114 row_newbcast:13 row_mask:0xf bank_mask:0xf
    v_dot2c_f32_bf16_dpp v15, v31, v115 row_newbcast:13 row_mask:0xf bank_mask:0xf
    s_waitcnt vmcnt(3)
    buffer_load_dwordx4 v[200:203], v4, s[36:39], s60 offen
    s_add_u32 s60, s60, 8192
    s_and_b32 s60, s60, 262143
    v_dot2c_f32_bf16_dpp v8, v30, v116 row_newbcast:14 row_mask:0xf bank_mask:0xf
    v_dot2c_f32_bf16_dpp v10, v30, v117 row_newbcast:14 row_mask:0xf bank_mask:0xf
    v_dot2c_f32_bf16_dpp v12, v30, v118 row_newbcast:14 row_mask:0xf bank_mask:0xf
    v_dot2c_f32_bf16_dpp v14, v30, v119 row_newbcast:14 row_mask:0xf bank_mask:0xf
    v_dot2c_f32_bf16_dpp v9, v31, v116 row_newbcast:14 row_mask:0xf bank_mask:0xf
    v_dot2c_f32_bf16_dpp v11, v31, v117 row_newbcast:14 row_mask:0xf bank_mask:0xf
    v_dot2c_f32_bf16_dpp v13, v31, v118 row_newbcast:14 row_mask:0xf bank_mask:0xf
    v_dot2c_f32_bf16_dpp v15, v31, v119 row_newbcast:14 row_mask:0xf bank_mask:0xf
    v_perm_b32 v187, v196, v192, s77
    v_perm_b32 v196, v196, v192, s61
    s_waitcnt vmcnt(3)
    buffer_load_dwordx4 v[52:55], v2, s[28:31], s56 offen offset:1024 nt
    buffer_load_dwordx4 v[56:59], v2, s[28:31], s56 offen offset:2048 nt
    v_dot2c_f32_bf16_dpp v8, v30, v120 row_newbcast:15 row_mask:0xf bank_mask:0xf
    v_dot2c_f32_bf16_dpp v10, v30, v121 row_newbcast:15 row_mask:0xf bank_mask:0xf
    v_dot2c_f32_bf16_dpp v12, v30, v122 row_newbcast:15 row_mask:0xf bank_mask:0xf
    v_dot2c_f32_bf16_dpp v14, v30, v123 row_newbcast:15 row_mask:0xf bank_mask:0xf
    v_dot2c_f32_bf16_dpp v9, v31, v120 row_newbcast:15 row_mask:0xf bank_mask:0xf
    v_dot2c_f32_bf16_dpp v11, v31, v121 row_newbcast:15 row_mask:0xf bank_mask:0xf
    v_dot2c_f32_bf16_dpp v13, v31, v122 row_newbcast:15 row_mask:0xf bank_mask:0xf
    v_dot2c_f32_bf16_dpp v15, v31, v123 row_newbcast:15 row_mask:0xf bank_mask:0xf
    v_perm_b32 v192, v197, v193, s77
    v_perm_b32 v197, v197, v193, s61
    s_waitcnt vmcnt(4)
    buffer_load_dwordx4 v[60:63], v2, s[28:31], s56 offen offset:3072 nt
    s_add_u32 s56, s56, 32768
    v_dot2c_f32_bf16_dpp v16, v28, v124 row_newbcast:3 row_mask:0xf bank_mask:0xf
    v_dot2c_f32_bf16_dpp v18, v28, v125 row_newbcast:3 row_mask:0xf bank_mask:0xf
    v_dot2c_f32_bf16_dpp v20, v28, v126 row_newbcast:3 row_mask:0xf bank_mask:0xf
    v_dot2c_f32_bf16_dpp v22, v28, v127 row_newbcast:3 row_mask:0xf bank_mask:0xf
    v_dot2c_f32_bf16_dpp v17, v29, v124 row_newbcast:3 row_mask:0xf bank_mask:0xf
    v_dot2c_f32_bf16_dpp v19, v29, v125 row_newbcast:3 row_mask:0xf bank_mask:0xf
    v_dot2c_f32_bf16_dpp v21, v29, v126 row_newbcast:3 row_mask:0xf bank_mask:0xf
    v_dot2c_f32_bf16_dpp v23, v29, v127 row_newbcast:3 row_mask:0xf bank_mask:0xf
    v_perm_b32 v193, v198, v194, s77
    v_perm_b32 v198, v198, v194, s61
    s_barrier
    s_waitcnt lgkmcnt(0)
    ds_read_b32 v30, v5
    ds_read_b32 v28, v6
    v_add_u32 v5, 256, v5
    v_add_u32 v6, 64, v6
    v_and_or_b32 v6, v6, s95, v1
    s_waitcnt lgkmcnt(0)
    v_lshlrev_b32 v31, 16, v30
    v_lshlrev_b32 v29, 16, v28
    s_waitcnt vmcnt(4)
    buffer_load_dwordx4 v[64:67], v3, s[32:35], s57 offen
    s_add_u32 s57, s57, s58
    s_cmp_ge_u32 s57, s76
    s_cselect_b32 s57, 0, s57
    v_dot2c_f32_bf16_dpp v8, v30, v48 row_newbcast:0 row_mask:0xf bank_mask:0xf
    v_dot2c_f32_bf16_dpp v10, v30, v49 row_newbcast:0 row_mask:0xf bank_mask:0xf
    v_dot2c_f32_bf16_dpp v12, v30, v50 row_newbcast:0 row_mask:0xf bank_mask:0xf
    v_dot2c_f32_bf16_dpp v14, v30, v51 row_newbcast:0 row_mask:0xf bank_mask:0xf
    v_dot2c_f32_bf16_dpp v9, v31, v48 row_newbcast:0 row_mask:0xf bank_mask:0xf
    v_dot2c_f32_bf16_dpp v11, v31, v49 row_newbcast:0 row_mask:0xf bank_mask:0xf
    v_dot2c_f32_bf16_dpp v13, v31, v50 row_newbcast:0 row_mask:0xf bank_mask:0xf
    v_dot2c_f32_bf16_dpp v15, v31, v51 row_newbcast:0 row_mask:0xf bank_mask:0xf
    v_perm_b32 v194, v199, v195, s77
    v_perm_b32 v199, v199, v195, s61
    s_waitcnt vmcnt(3)
    buffer_load_dwordx4 v[204:207], v4, s[36:39], s60 offen
    s_add_u32 s60, s60, 8192
    s_and_b32 s60, s60, 262143
    v_dot2c_f32_bf16_dpp v8, v30, v52 row_newbcast:1 row_mask:0xf bank_mask:0xf
    v_dot2c_f32_bf16_dpp v10, v30, v53 row_newbcast:1 row_mask:0xf bank_mask:0xf
    v_dot2c_f32_bf16_dpp v12, v30, v54 row_newbcast:1 row_mask:0xf bank_mask:0xf
    v_dot2c_f32_bf16_dpp v14, v30, v55 row_newbcast:1 row_mask:0xf bank_mask:0xf
    v_dot2c_f32_bf16_dpp v9, v31, v52 row_newbcast:1 row_mask:0xf bank_mask:0xf
    v_dot2c_f32_bf16_dpp v11, v31, v53 row_newbcast:1 row_mask:0xf bank_mask:0xf
    v_dot2c_f32_bf16_dpp v13, v31, v54 row_newbcast:1 row_mask:0xf bank_mask:0xf
    v_dot2c_f32_bf16_dpp v15, v31, v55 row_newbcast:1 row_mask:0xf bank_mask:0xf
    s_waitcnt vmcnt(3)
    buffer_load_dwordx4 v[68:71], v2, s[28:31], s56 offen nt
    buffer_load_dwordx4 v[72:75], v2, s[28:31], s56 offen offset:1024 nt
    v_dot2c_f32_bf16_dpp v8, v30, v56 row_newbcast:2 row_mask:0xf bank_mask:0xf
    v_dot2c_f32_bf16_dpp v10, v30, v57 row_newbcast:2 row_mask:0xf bank_mask:0xf
    v_dot2c_f32_bf16_dpp v12, v30, v58 row_newbcast:2 row_mask:0xf bank_mask:0xf
    v_dot2c_f32_bf16_dpp v14, v30, v59 row_newbcast:2 row_mask:0xf bank_mask:0xf
    v_dot2c_f32_bf16_dpp v9, v31, v56 row_newbcast:2 row_mask:0xf bank_mask:0xf
    v_dot2c_f32_bf16_dpp v11, v31, v57 row_newbcast:2 row_mask:0xf bank_mask:0xf
    v_dot2c_f32_bf16_dpp v13, v31, v58 row_newbcast:2 row_mask:0xf bank_mask:0xf
    v_dot2c_f32_bf16_dpp v15, v31, v59 row_newbcast:2 row_mask:0xf bank_mask:0xf
    s_waitcnt vmcnt(4)
    v_dot2c_f32_bf16_dpp v8, v30, v60 row_newbcast:3 row_mask:0xf bank_mask:0xf
    v_dot2c_f32_bf16_dpp v10, v30, v61 row_newbcast:3 row_mask:0xf bank_mask:0xf
    v_dot2c_f32_bf16_dpp v12, v30, v62 row_newbcast:3 row_mask:0xf bank_mask:0xf
    v_dot2c_f32_bf16_dpp v14, v30, v63 row_newbcast:3 row_mask:0xf bank_mask:0xf
    v_dot2c_f32_bf16_dpp v9, v31, v60 row_newbcast:3 row_mask:0xf bank_mask:0xf
    v_dot2c_f32_bf16_dpp v11, v31, v61 row_newbcast:3 row_mask:0xf bank_mask:0xf
    v_dot2c_f32_bf16_dpp v13, v31, v62 row_newbcast:3 row_mask:0xf bank_mask:0xf
    v_dot2c_f32_bf16_dpp v15, v31, v63 row_newbcast:3 row_mask:0xf bank_mask:0xf
    s_waitcnt vmcnt(3)
    buffer_load_dwordx4 v[76:79], v2, s[28:31], s56 offen offset:2048 nt
    buffer_load_dwordx4 v[80:83], v2, s[28:31], s56 offen offset:3072 nt
    s_add_u32 s56, s56, 32768
    v_dot2c_f32_bf16_dpp v16, v28, v64 row_newbcast:0 row_mask:0xf bank_mask:0xf
    v_dot2c_f32_bf16_dpp v18, v28, v65 row_newbcast:0 row_mask:0xf bank_mask:0xf
    v_dot2c_f32_bf16_dpp v20, v28, v66 row_newbcast:0 row_mask:0xf bank_mask:0xf
    v_dot2c_f32_bf16_dpp v22, v28, v67 row_newbcast:0 row_mask:0xf bank_mask:0xf
    v_dot2c_f32_bf16_dpp v17, v29, v64 row_newbcast:0 row_mask:0xf bank_mask:0xf
    v_dot2c_f32_bf16_dpp v19, v29, v65 row_newbcast:0 row_mask:0xf bank_mask:0xf
    v_dot2c_f32_bf16_dpp v21, v29, v66 row_newbcast:0 row_mask:0xf bank_mask:0xf
    v_dot2c_f32_bf16_dpp v23, v29, v67 row_newbcast:0 row_mask:0xf bank_mask:0xf
    s_waitcnt vmcnt(3)
    buffer_load_dwordx4 v[208:211], v4, s[36:39], s60 offen
    s_add_u32 s60, s60, 8192
    s_and_b32 s60, s60, 262143
    v_dot2c_f32_bf16_dpp v8, v30, v68 row_newbcast:4 row_mask:0xf bank_mask:0xf
    v_dot2c_f32_bf16_dpp v10, v30, v69 row_newbcast:4 row_mask:0xf bank_mask:0xf
    v_dot2c_f32_bf16_dpp v12, v30, v70 row_newbcast:4 row_mask:0xf bank_mask:0xf
    v_dot2c_f32_bf16_dpp v14, v30, v71 row_newbcast:4 row_mask:0xf bank_mask:0xf
    v_dot2c_f32_bf16_dpp v9, v31, v68 row_newbcast:4 row_mask:0xf bank_mask:0xf
    v_dot2c_f32_bf16_dpp v11, v31, v69 row_newbcast:4 row_mask:0xf bank_mask:0xf
    v_dot2c_f32_bf16_dpp v13, v31, v70 row_newbcast:4 row_mask:0xf bank_mask:0xf
    v_dot2c_f32_bf16_dpp v15, v31, v71 row_newbcast:4 row_mask:0xf bank_mask:0xf
    v_perm_b32 v195, v204, v200, s77
    v_perm_b32 v204, v204, v200, s61
    s_waitcnt vmcnt(3)
    buffer_load_dwordx4 v[84:87], v3, s[32:35], s57 offen
    s_add_u32 s57, s57, s58
    s_cmp_ge_u32 s57, s76
    s_cselect_b32 s57, 0, s57
    buffer_load_dwordx4 v[88:91], v2, s[28:31], s56 offen nt
    v_dot2c_f32_bf16_dpp v8, v30, v72 row_newbcast:5 row_mask:0xf bank_mask:0xf
    v_dot2c_f32_bf16_dpp v10, v30, v73 row_newbcast:5 row_mask:0xf bank_mask:0xf
    v_dot2c_f32_bf16_dpp v12, v30, v74 row_newbcast:5 row_mask:0xf bank_mask:0xf
    v_dot2c_f32_bf16_dpp v14, v30, v75 row_newbcast:5 row_mask:0xf bank_mask:0xf
    v_dot2c_f32_bf16_dpp v9, v31, v72 row_newbcast:5 row_mask:0xf bank_mask:0xf
    v_dot2c_f32_bf16_dpp v11, v31, v73 row_newbcast:5 row_mask:0xf bank_mask:0xf
    v_dot2c_f32_bf16_dpp v13, v31, v74 row_newbcast:5 row_mask:0xf bank_mask:0xf
    v_dot2c_f32_bf16_dpp v15, v31, v75 row_newbcast:5 row_mask:0xf bank_mask:0xf
    v_perm_b32 v200, v205, v201, s77
    v_perm_b32 v205, v205, v201, s61
    s_waitcnt vmcnt(4)
    v_dot2c_f32_bf16_dpp v8, v30, v76 row_newbcast:6 row_mask:0xf bank_mask:0xf
    v_dot2c_f32_bf16_dpp v10, v30, v77 row_newbcast:6 row_mask:0xf bank_mask:0xf
    v_dot2c_f32_bf16_dpp v12, v30, v78 row_newbcast:6 row_mask:0xf bank_mask:0xf
    v_dot2c_f32_bf16_dpp v14, v30, v79 row_newbcast:6 row_mask:0xf bank_mask:0xf
    v_dot2c_f32_bf16_dpp v9, v31, v76 row_newbcast:6 row_mask:0xf bank_mask:0xf
    v_dot2c_f32_bf16_dpp v11, v31, v77 row_newbcast:6 row_mask:0xf bank_mask:0xf
    v_dot2c_f32_bf16_dpp v13, v31, v78 row_newbcast:6 row_mask:0xf bank_mask:0xf
    v_dot2c_f32_bf16_dpp v15, v31, v79 row_newbcast:6 row_mask:0xf bank_mask:0xf
    v_perm_b32 v201, v206, v202, s77
    v_perm_b32 v206, v206, v202, s61
    s_waitcnt vmcnt(3)
    buffer_load_dwordx4 v[92:95], v2, s[28:31], s56 offen offset:1024 nt
    buffer_load_dwordx4 v[96:99], v2, s[28:31], s56 offen offset:2048 nt
    v_dot2c_f32_bf16_dpp v8, v30, v80 row_newbcast:7 row_mask:0xf bank_mask:0xf
    v_dot2c_f32_bf16_dpp v10, v30, v81 row_newbcast:7 row_mask:0xf bank_mask:0xf
    v_dot2c_f32_bf16_dpp v12, v30, v82 row_newbcast:7 row_mask:0xf bank_mask:0xf
    v_dot2c_f32_bf16_dpp v14, v30, v83 row_newbcast:7 row_mask:0xf bank_mask:0xf
    v_dot2c_f32_bf16_dpp v9, v31, v80 row_newbcast:7 row_mask:0xf bank_mask:0xf
    v_dot2c_f32_bf16_dpp v11, v31, v81 row_newbcast:7 row_mask:0xf bank_mask:0xf
    v_dot2c_f32_bf16_dpp v13, v31, v82 row_newbcast:7 row_mask:0xf bank_mask:0xf
    v_dot2c_f32_bf16_dpp v15, v31, v83 row_newbcast:7 row_mask:0xf bank_mask:0xf
    v_perm_b32 v202, v207, v203, s77
    v_perm_b32 v207, v207, v203, s61
    s_waitcnt vmcnt(3)
    buffer_load_dwordx4 v[212:215], v4, s[36:39], s60 offen
    s_add_u32 s60, s60, 8192
    s_and_b32 s60, s60, 262143
    v_dot2c_f32_bf16_dpp v16, v28, v84 row_newbcast:1 row_mask:0xf bank_mask:0xf
    v_dot2c_f32_bf16_dpp v18, v28, v85 row_newbcast:1 row_mask:0xf bank_mask:0xf
    v_dot2c_f32_bf16_dpp v20, v28, v86 row_newbcast:1 row_mask:0xf bank_mask:0xf
    v_dot2c_f32_bf16_dpp v22, v28, v87 row_newbcast:1 row_mask:0xf bank_mask:0xf
    v_dot2c_f32_bf16_dpp v17, v29, v84 row_newbcast:1 row_mask:0xf bank_mask:0xf
    v_dot2c_f32_bf16_dpp v19, v29, v85 row_newbcast:1 row_mask:0xf bank_mask:0xf
    v_dot2c_f32_bf16_dpp v21, v29, v86 row_newbcast:1 row_mask:0xf bank_mask:0xf
    v_dot2c_f32_bf16_dpp v23, v29, v87 row_newbcast:1 row_mask:0xf bank_mask:0xf
    s_waitcnt vmcnt(3)
    buffer_load_dwordx4 v[100:103], v2, s[28:31], s56 offen offset:3072 nt
    s_add_u32 s56, s56, 32768
    buffer_load_dwordx4 v[104:107], v3, s[32:35], s57 offen
    s_add_u32 s57, s57, s58
    s_cmp_ge_u32 s57, s76
    s_cselect_b32 s57, 0, s57
    v_dot2c_f32_bf16_dpp v8, v30, v88 row_newbcast:8 row_mask:0xf bank_mask:0xf
    v_dot2c_f32_bf16_dpp v10, v30, v89 row_newbcast:8 row_mask:0xf bank_mask:0xf
    v_dot2c_f32_bf16_dpp v12, v30, v90 row_newbcast:8 row_mask:0xf bank_mask:0xf
    v_dot2c_f32_bf16_dpp v14, v30, v91 row_newbcast:8 row_mask:0xf bank_mask:0xf
    v_dot2c_f32_bf16_dpp v9, v31, v88 row_newbcast:8 row_mask:0xf bank_mask:0xf
    v_dot2c_f32_bf16_dpp v11, v31, v89 row_newbcast:8 row_mask:0xf bank_mask:0xf
    v_dot2c_f32_bf16_dpp v13, v31, v90 row_newbcast:8 row_mask:0xf bank_mask:0xf
    v_dot2c_f32_bf16_dpp v15, v31, v91 row_newbcast:8 row_mask:0xf bank_mask:0xf
    s_waitcnt vmcnt(4)
    v_dot2c_f32_bf16_dpp v8, v30, v92 row_newbcast:9 row_mask:0xf bank_mask:0xf
    v_dot2c_f32_bf16_dpp v10, v30, v93 row_newbcast:9 row_mask:0xf bank_mask:0xf
    v_dot2c_f32_bf16_dpp v12, v30, v94 row_newbcast:9 row_mask:0xf bank_mask:0xf
    v_dot2c_f32_bf16_dpp v14, v30, v95 row_newbcast:9 row_mask:0xf bank_mask:0xf
    v_dot2c_f32_bf16_dpp v9, v31, v92 row_newbcast:9 row_mask:0xf bank_mask:0xf
    v_dot2c_f32_bf16_dpp v11, v31, v93 row_newbcast:9 row_mask:0xf bank_mask:0xf
    v_dot2c_f32_bf16_dpp v13, v31, v94 row_newbcast:9 row_mask:0xf bank_mask:0xf
    v_dot2c_f32_bf16_dpp v15, v31, v95 row_newbcast:9 row_mask:0xf bank_mask:0xf
    s_waitcnt vmcnt(3)
    buffer_load_dwordx4 v[108:111], v2, s[28:31], s56 offen nt
    buffer_load_dwordx4 v[112:115], v2, s[28:31], s56 offen offset:1024 nt
    v_dot2c_f32_bf16_dpp v8, v30, v96 row_newbcast:10 row_mask:0xf bank_mask:0xf
    v_dot2c_f32_bf16_dpp v10, v30, v97 row_newbcast:10 row_mask:0xf bank_mask:0xf
    v_dot2c_f32_bf16_dpp v12, v30, v98 row_newbcast:10 row_mask:0xf bank_mask:0xf
    v_dot2c_f32_bf16_dpp v14, v30, v99 row_newbcast:10 row_mask:0xf bank_mask:0xf
    v_dot2c_f32_bf16_dpp v9, v31, v96 row_newbcast:10 row_mask:0xf bank_mask:0xf
    v_dot2c_f32_bf16_dpp v11, v31, v97 row_newbcast:10 row_mask:0xf bank_mask:0xf
    v_dot2c_f32_bf16_dpp v13, v31, v98 row_newbcast:10 row_mask:0xf bank_mask:0xf
    v_dot2c_f32_bf16_dpp v15, v31, v99 row_newbcast:10 row_mask:0xf bank_mask:0xf
    s_waitcnt vmcnt(3)
    buffer_load_dwordx4 v[216:219], v4, s[36:39], s60 offen
    s_add_u32 s60, s60, 8192
    s_and_b32 s60, s60, 262143
    v_dot2c_f32_bf16_dpp v8, v30, v100 row_newbcast:11 row_mask:0xf bank_mask:0xf
    v_dot2c_f32_bf16_dpp v10, v30, v101 row_newbcast:11 row_mask:0xf bank_mask:0xf
    v_dot2c_f32_bf16_dpp v12, v30, v102 row_newbcast:11 row_mask:0xf bank_mask:0xf
    v_dot2c_f32_bf16_dpp v14, v30, v103 row_newbcast:11 row_mask:0xf bank_mask:0xf
    v_dot2c_f32_bf16_dpp v9, v31, v100 row_newbcast:11 row_mask:0xf bank_mask:0xf
    v_dot2c_f32_bf16_dpp v11, v31, v101 row_newbcast:11 row_mask:0xf bank_mask:0xf
    v_dot2c_f32_bf16_dpp v13, v31, v102 row_newbcast:11 row_mask:0xf bank_mask:0xf
    v_dot2c_f32_bf16_dpp v15, v31, v103 row_newbcast:11 row_mask:0xf bank_mask:0xf
    v_perm_b32 v203, v212, v208, s77
    v_perm_b32 v212, v212, v208, s61
    s_waitcnt vmcnt(3)
    buffer_load_dwordx4 v[116:119], v2, s[28:31], s56 offen offset:2048 nt
    buffer_load_dwordx4 v[120:123], v2, s[28:31], s56 offen offset:3072 nt
    s_add_u32 s56, s56, 32768
    v_dot2c_f32_bf16_dpp v16, v28, v104 row_newbcast:2 row_mask:0xf bank_mask:0xf
    v_dot2c_f32_bf16_dpp v18, v28, v105 row_newbcast:2 row_mask:0xf bank_mask:0xf
    v_dot2c_f32_bf16_dpp v20, v28, v106 row_newbcast:2 row_mask:0xf bank_mask:0xf
    v_dot2c_f32_bf16_dpp v22, v28, v107 row_newbcast:2 row_mask:0xf bank_mask:0xf
    v_dot2c_f32_bf16_dpp v17, v29, v104 row_newbcast:2 row_mask:0xf bank_mask:0xf
    v_dot2c_f32_bf16_dpp v19, v29, v105 row_newbcast:2 row_mask:0xf bank_mask:0xf
    v_dot2c_f32_bf16_dpp v21, v29, v106 row_newbcast:2 row_mask:0xf bank_mask:0xf
    v_dot2c_f32_bf16_dpp v23, v29, v107 row_newbcast:2 row_mask:0xf bank_mask:0xf
    v_perm_b32 v208, v213, v209, s77
    v_perm_b32 v213, v213, v209, s61
    s_waitcnt vmcnt(4)
    v_dot2c_f32_bf16_dpp v8, v30, v108 row_newbcast:12 row_mask:0xf bank_mask:0xf
    v_dot2c_f32_bf16_dpp v10, v30, v109 row_newbcast:12 row_mask:0xf bank_mask:0xf
    v_dot2c_f32_bf16_dpp v12, v30, v110 row_newbcast:12 row_mask:0xf bank_mask:0xf
    v_dot2c_f32_bf16_dpp v14, v30, v111 row_newbcast:12 row_mask:0xf bank_mask:0xf
    v_dot2c_f32_bf16_dpp v9, v31, v108 row_newbcast:12 row_mask:0xf bank_mask:0xf
    v_dot2c_f32_bf16_dpp v11, v31, v109 row_newbcast:12 row_mask:0xf bank_mask:0xf
    v_dot2c_f32_bf16_dpp v13, v31, v110 row_newbcast:12 row_mask:0xf bank_mask:0xf
    v_dot2c_f32_bf16_dpp v15, v31, v111 row_newbcast:12 row_mask:0xf bank_mask:0xf
    v_perm_b32 v209, v214, v210, s77
    v_perm_b32 v214, v214, v210, s61
    s_waitcnt vmcnt(3)
    buffer_load_dwordx4 v[124:127], v3, s[32:35], s57 offen
    s_add_u32 s57, s57, s58
    s_cmp_ge_u32 s57, s76
    s_cselect_b32 s57, 0, s57
    buffer_load_dwordx4 v[48:51], v2, s[28:31], s56 offen nt
    v_dot2c_f32_bf16_dpp v8, v30, v112 row_newbcast:13 row_mask:0xf bank_mask:0xf
    v_dot2c_f32_bf16_dpp v10, v30, v113 row_newbcast:13 row_mask:0xf bank_mask:0xf
    v_dot2c_f32_bf16_dpp v12, v30, v114 row_newbcast:13 row_mask:0xf bank_mask:0xf
    v_dot2c_f32_bf16_dpp v14, v30, v115 row_newbcast:13 row_mask:0xf bank_mask:0xf
    v_dot2c_f32_bf16_dpp v9, v31, v112 row_newbcast:13 row_mask:0xf bank_mask:0xf
    v_dot2c_f32_bf16_dpp v11, v31, v113 row_newbcast:13 row_mask:0xf bank_mask:0xf
    v_dot2c_f32_bf16_dpp v13, v31, v114 row_newbcast:13 row_mask:0xf bank_mask:0xf
    v_dot2c_f32_bf16_dpp v15, v31, v115 row_newbcast:13 row_mask:0xf bank_mask:0xf
    v_perm_b32 v210, v215, v211, s77
    v_perm_b32 v215, v215, v211, s61
    s_waitcnt vmcnt(3)
    buffer_load_dwordx4 v[220:223], v4, s[36:39], s60 offen
    s_add_u32 s60, s60, 8192
    s_and_b32 s60, s60, 262143
    v_dot2c_f32_bf16_dpp v8, v30, v116 row_newbcast:14 row_mask:0xf bank_mask:0xf
    v_dot2c_f32_bf16_dpp v10, v30, v117 row_newbcast:14 row_mask:0xf bank_mask:0xf
    v_dot2c_f32_bf16_dpp v12, v30, v118 row_newbcast:14 row_mask:0xf bank_mask:0xf
    v_dot2c_f32_bf16_dpp v14, v30, v119 row_newbcast:14 row_mask:0xf bank_mask:0xf
    v_dot2c_f32_bf16_dpp v9, v31, v116 row_newbcast:14 row_mask:0xf bank_mask:0xf
    v_dot2c_f32_bf16_dpp v11, v31, v117 row_newbcast:14 row_mask:0xf bank_mask:0xf
    v_dot2c_f32_bf16_dpp v13, v31, v118 row_newbcast:14 row_mask:0xf bank_mask:0xf
    v_dot2c_f32_bf16_dpp v15, v31, v119 row_newbcast:14 row_mask:0xf bank_mask:0xf
    s_waitcnt vmcnt(3)
    buffer_load_dwordx4 v[52:55], v2, s[28:31], s56 offen offset:1024 nt
    buffer_load_dwordx4 v[56:59], v2, s[28:31], s56 offen offset:2048 nt
    v_dot2c_f32_bf16_dpp v8, v30, v120 row_newbcast:15 row_mask:0xf bank_mask:0xf
    v_dot2c_f32_bf16_dpp v10, v30, v121 row_newbcast:15 row_mask:0xf bank_mask:0xf
    v_dot2c_f32_bf16_dpp v12, v30, v122 row_newbcast:15 row_mask:0xf bank_mask:0xf
    v_dot2c_f32_bf16_dpp v14, v30, v123 row_newbcast:15 row_mask:0xf bank_mask:0xf
    v_dot2c_f32_bf16_dpp v9, v31, v120 row_newbcast:15 row_mask:0xf bank_mask:0xf
    v_dot2c_f32_bf16_dpp v11, v31, v121 row_newbcast:15 row_mask:0xf bank_mask:0xf
    v_dot2c_f32_bf16_dpp v13, v31, v122 row_newbcast:15 row_mask:0xf bank_mask:0xf
    v_dot2c_f32_bf16_dpp v15, v31, v123 row_newbcast:15 row_mask:0xf bank_mask:0xf
    s_waitcnt vmcnt(4)
    buffer_load_dwordx4 v[60:63], v2, s[28:31], s56 offen offset:3072 nt
    s_add_u32 s56, s56, 32768
    v_dot2c_f32_bf16_dpp v16, v28, v124 row_newbcast:3 row_mask:0xf bank_mask:0xf
    v_dot2c_f32_bf16_dpp v18, v28, v125 row_newbcast:3 row_mask:0xf bank_mask:0xf
    v_dot2c_f32_bf16_dpp v20, v28, v126 row_newbcast:3 row_mask:0xf bank_mask:0xf
    v_dot2c_f32_bf16_dpp v22, v28, v127 row_newbcast:3 row_mask:0xf bank_mask:0xf
    v_dot2c_f32_bf16_dpp v17, v29, v124 row_newbcast:3 row_mask:0xf bank_mask:0xf
    v_dot2c_f32_bf16_dpp v19, v29, v125 row_newbcast:3 row_mask:0xf bank_mask:0xf
    v_dot2c_f32_bf16_dpp v21, v29, v126 row_newbcast:3 row_mask:0xf bank_mask:0xf
    v_dot2c_f32_bf16_dpp v23, v29, v127 row_newbcast:3 row_mask:0xf bank_mask:0xf
    s_barrier
    s_waitcnt lgkmcnt(0)
    ds_read_b32 v30, v5
    ds_read_b32 v28, v6
    v_add_u32 v5, 256, v5
    v_add_u32 v6, 64, v6
    v_and_or_b32 v6, v6, s95, v1
    s_waitcnt lgkmcnt(0)
    v_lshlrev_b32 v31, 16, v30
    v_lshlrev_b32 v29, 16, v28
    s_waitcnt vmcnt(4)
    buffer_load_dwordx4 v[64:67], v3, s[32:35], s57 offen
    s_add_u32 s57, s57, s58
    s_cmp_ge_u32 s57, s76
    s_cselect_b32 s57, 0, s57
    v_dot2c_f32_bf16_dpp v8, v30, v48 row_newbcast:0 row_mask:0xf bank_mask:0xf
    v_dot2c_f32_bf16_dpp v10, v30, v49 row_newbcast:0 row_mask:0xf bank_mask:0xf
    v_dot2c_f32_bf16_dpp v12, v30, v50 row_newbcast:0 row_mask:0xf bank_mask:0xf
    v_dot2c_f32_bf16_dpp v14, v30, v51 row_newbcast:0 row_mask:0xf bank_mask:0xf
    v_dot2c_f32_bf16_dpp v9, v31, v48 row_newbcast:0 row_mask:0xf bank_mask:0xf
    v_dot2c_f32_bf16_dpp v11, v31, v49 row_newbcast:0 row_mask:0xf bank_mask:0xf
    v_dot2c_f32_bf16_dpp v13, v31, v50 row_newbcast:0 row_mask:0xf bank_mask:0xf
    v_dot2c_f32_bf16_dpp v15, v31, v51 row_newbcast:0 row_mask:0xf bank_mask:0xf
    s_waitcnt vmcnt(3)
    buffer_load_dwordx4 v[224:227], v4, s[36:39], s60 offen
    s_add_u32 s60, s60, 8192
    s_and_b32 s60, s60, 262143
    v_dot2c_f32_bf16_dpp v8, v30, v52 row_newbcast:1 row_mask:0xf bank_mask:0xf
    v_dot2c_f32_bf16_dpp v10, v30, v53 row_newbcast:1 row_mask:0xf bank_mask:0xf
    v_dot2c_f32_bf16_dpp v12, v30, v54 row_newbcast:1 row_mask:0xf bank_mask:0xf
    v_dot2c_f32_bf16_dpp v14, v30, v55 row_newbcast:1 row_mask:0xf bank_mask:0xf
    v_dot2c_f32_bf16_dpp v9, v31, v52 row_newbcast:1 row_mask:0xf bank_mask:0xf
    v_dot2c_f32_bf16_dpp v11, v31, v53 row_newbcast:1 row_mask:0xf bank_mask:0xf
    v_dot2c_f32_bf16_dpp v13, v31, v54 row_newbcast:1 row_mask:0xf bank_mask:0xf
    v_dot2c_f32_bf16_dpp v15, v31, v55 row_newbcast:1 row_mask:0xf bank_mask:0xf
    v_perm_b32 v211, v220, v216, s77
    v_perm_b32 v220, v220, v216, s61
    s_waitcnt vmcnt(3)
    buffer_load_dwordx4 v[68:71], v2, s[28:31], s56 offen nt
    buffer_load_dwordx4 v[72:75], v2, s[28:31], s56 offen offset:1024 nt
    v_dot2c_f32_bf16_dpp v8, v30, v56 row_newbcast:2 row_mask:0xf bank_mask:0xf
    v_dot2c_f32_bf16_dpp v10, v30, v57 row_newbcast:2 row_mask:0xf bank_mask:0xf
    v_dot2c_f32_bf16_dpp v12, v30, v58 row_newbcast:2 row_mask:0xf bank_mask:0xf
    v_dot2c_f32_bf16_dpp v14, v30, v59 row_newbcast:2 row_mask:0xf bank_mask:0xf
    v_dot2c_f32_bf16_dpp v9, v31, v56 row_newbcast:2 row_mask:0xf bank_mask:0xf
    v_dot2c_f32_bf16_dpp v11, v31, v57 row_newbcast:2 row_mask:0xf bank_mask:0xf
    v_dot2c_f32_bf16_dpp v13, v31, v58 row_newbcast:2 row_mask:0xf bank_mask:0xf
    v_dot2c_f32_bf16_dpp v15, v31, v59 row_newbcast:2 row_mask:0xf bank_mask:0xf
    v_perm_b32 v216, v221, v217, s77
    v_perm_b32 v221, v221, v217, s61
    s_waitcnt vmcnt(4)
    v_dot2c_f32_bf16_dpp v8, v30, v60 row_newbcast:3 row_mask:0xf bank_mask:0xf
    v_dot2c_f32_bf16_dpp v10, v30, v61 row_newbcast:3 row_mask:0xf bank_mask:0xf
    v_dot2c_f32_bf16_dpp v12, v30, v62 row_newbcast:3 row_mask:0xf bank_mask:0xf
    v_dot2c_f32_bf16_dpp v14, v30, v63 row_newbcast:3 row_mask:0xf bank_mask:0xf
    v_dot2c_f32_bf16_dpp v9, v31, v60 row_newbcast:3 row_mask:0xf bank_mask:0xf
    v_dot2c_f32_bf16_dpp v11, v31, v61 row_newbcast:3 row_mask:0xf bank_mask:0xf
    v_dot2c_f32_bf16_dpp v13, v31, v62 row_newbcast:3 row_mask:0xf bank_mask:0xf
    v_dot2c_f32_bf16_dpp v15, v31, v63 row_newbcast:3 row_mask:0xf bank_mask:0xf
    v_perm_b32 v217, v222, v218, s77
    v_perm_b32 v222, v222, v218, s61
    s_waitcnt vmcnt(3)
    buffer_load_dwordx4 v[76:79], v2, s[28:31], s56 offen offset:2048 nt
    buffer_load_dwordx4 v[80:83], v2, s[28:31], s56 offen offset:3072 nt
    s_add_u32 s56, s56, 32768
    v_dot2c_f32_bf16_dpp v16, v28, v64 row_newbcast:0 row_mask:0xf bank_mask:0xf
    v_dot2c_f32_bf16_dpp v18, v28, v65 row_newbcast:0 row_mask:0xf bank_mask:0xf
    v_dot2c_f32_bf16_dpp v20, v28, v66 row_newbcast:0 row_mask:0xf bank_mask:0xf
    v_dot2c_f32_bf16_dpp v22, v28, v67 row_newbcast:0 row_mask:0xf bank_mask:0xf
    v_dot2c_f32_bf16_dpp v17, v29, v64 row_newbcast:0 row_mask:0xf bank_mask:0xf
    v_dot2c_f32_bf16_dpp v19, v29, v65 row_newbcast:0 row_mask:0xf bank_mask:0xf
    v_dot2c_f32_bf16_dpp v21, v29, v66 row_newbcast:0 row_mask:0xf bank_mask:0xf
    v_dot2c_f32_bf16_dpp v23, v29, v67 row_newbcast:0 row_mask:0xf bank_mask:0xf
    v_perm_b32 v218, v223, v219, s77
    v_perm_b32 v223, v223, v219, s61
    s_waitcnt vmcnt(3)
    buffer_load_dwordx4 v[228:231], v4, s[36:39], s60 offen
    s_add_u32 s60, s60, 8192
    s_and_b32 s60, s60, 262143
    v_dot2c_f32_bf16_dpp v8, v30, v68 row_newbcast:4 row_mask:0xf bank_mask:0xf
    v_dot2c_f32_bf16_dpp v10, v30, v69 row_newbcast:4 row_mask:0xf bank_mask:0xf
    v_dot2c_f32_bf16_dpp v12, v30, v70 row_newbcast:4 row_mask:0xf bank_mask:0xf
    v_dot2c_f32_bf16_dpp v14, v30, v71 row_newbcast:4 row_mask:0xf bank_mask:0xf
    v_dot2c_f32_bf16_dpp v9, v31, v68 row_newbcast:4 row_mask:0xf bank_mask:0xf
    v_dot2c_f32_bf16_dpp v11, v31, v69 row_newbcast:4 row_mask:0xf bank_mask:0xf
    v_dot2c_f32_bf16_dpp v13, v31, v70 row_newbcast:4 row_mask:0xf bank_mask:0xf
    v_dot2c_f32_bf16_dpp v15, v31, v71 row_newbcast:4 row_mask:0xf bank_mask:0xf
    s_waitcnt vmcnt(3)
    buffer_load_dwordx4 v[84:87], v3, s[32:35], s57 offen
    s_add_u32 s57, s57, s58
    s_cmp_ge_u32 s57, s76
    s_cselect_b32 s57, 0, s57
    buffer_load_dwordx4 v[88:91], v2, s[28:31], s56 offen nt
    v_dot2c_f32_bf16_dpp v8, v30, v72 row_newbcast:5 row_mask:0xf bank_mask:0xf
    v_dot2c_f32_bf16_dpp v10, v30, v73 row_newbcast:5 row_mask:0xf bank_mask:0xf
    v_dot2c_f32_bf16_dpp v12, v30, v74 row_newbcast:5 row_mask:0xf bank_mask:0xf
    v_dot2c_f32_bf16_dpp v14, v30, v75 row_newbcast:5 row_mask:0xf bank_mask:0xf
    v_dot2c_f32_bf16_dpp v9, v31, v72 row_newbcast:5 row_mask:0xf bank_mask:0xf
    v_dot2c_f32_bf16_dpp v11, v31, v73 row_newbcast:5 row_mask:0xf bank_mask:0xf
    v_dot2c_f32_bf16_dpp v13, v31, v74 row_newbcast:5 row_mask:0xf bank_mask:0xf
    v_dot2c_f32_bf16_dpp v15, v31, v75 row_newbcast:5 row_mask:0xf bank_mask:0xf
    s_waitcnt vmcnt(4)
    v_dot2c_f32_bf16_dpp v8, v30, v76 row_newbcast:6 row_mask:0xf bank_mask:0xf
    v_dot2c_f32_bf16_dpp v10, v30, v77 row_newbcast:6 row_mask:0xf bank_mask:0xf
    v_dot2c_f32_bf16_dpp v12, v30, v78 row_newbcast:6 row_mask:0xf bank_mask:0xf
    v_dot2c_f32_bf16_dpp v14, v30, v79 row_newbcast:6 row_mask:0xf bank_mask:0xf
    v_dot2c_f32_bf16_dpp v9, v31, v76 row_newbcast:6 row_mask:0xf bank_mask:0xf
    v_dot2c_f32_bf16_dpp v11, v31, v77 row_newbcast:6 row_mask:0xf bank_mask:0xf
    v_dot2c_f32_bf16_dpp v13, v31, v78 row_newbcast:6 row_mask:0xf bank_mask:0xf
    v_dot2c_f32_bf16_dpp v15, v31, v79 row_newbcast:6 row_mask:0xf bank_mask:0xf
    s_waitcnt vmcnt(3)
    buffer_load_dwordx4 v[92:95], v2, s[28:31], s56 offen offset:1024 nt
    buffer_load_dwordx4 v[96:99], v2, s[28:31], s56 offen offset:2048 nt
    v_dot2c_f32_bf16_dpp v8, v30, v80 row_newbcast:7 row_mask:0xf bank_mask:0xf
    v_dot2c_f32_bf16_dpp v10, v30, v81 row_newbcast:7 row_mask:0xf bank_mask:0xf
    v_dot2c_f32_bf16_dpp v12, v30, v82 row_newbcast:7 row_mask:0xf bank_mask:0xf
    v_dot2c_f32_bf16_dpp v14, v30, v83 row_newbcast:7 row_mask:0xf bank_mask:0xf
    v_dot2c_f32_bf16_dpp v9, v31, v80 row_newbcast:7 row_mask:0xf bank_mask:0xf
    v_dot2c_f32_bf16_dpp v11, v31, v81 row_newbcast:7 row_mask:0xf bank_mask:0xf
    v_dot2c_f32_bf16_dpp v13, v31, v82 row_newbcast:7 row_mask:0xf bank_mask:0xf
    v_dot2c_f32_bf16_dpp v15, v31, v83 row_newbcast:7 row_mask:0xf bank_mask:0xf
    s_waitcnt vmcnt(3)
    buffer_load_dwordx4 v[232:235], v4, s[36:39], s60 offen
    s_add_u32 s60, s60, 8192
    s_and_b32 s60, s60, 262143
    v_dot2c_f32_bf16_dpp v16, v28, v84 row_newbcast:1 row_mask:0xf bank_mask:0xf
    v_dot2c_f32_bf16_dpp v18, v28, v85 row_newbcast:1 row_mask:0xf bank_mask:0xf
    v_dot2c_f32_bf16_dpp v20, v28, v86 row_newbcast:1 row_mask:0xf bank_mask:0xf
    v_dot2c_f32_bf16_dpp v22, v28, v87 row_newbcast:1 row_mask:0xf bank_mask:0xf
    v_dot2c_f32_bf16_dpp v17, v29, v84 row_newbcast:1 row_mask:0xf bank_mask:0xf
    v_dot2c_f32_bf16_dpp v19, v29, v85 row_newbcast:1 row_mask:0xf bank_mask:0xf
    v_dot2c_f32_bf16_dpp v21, v29, v86 row_newbcast:1 row_mask:0xf bank_mask:0xf
    v_dot2c_f32_bf16_dpp v23, v29, v87 row_newbcast:1 row_mask:0xf bank_mask:0xf
    v_perm_b32 v219, v228, v224, s77
    v_perm_b32 v228, v228, v224, s61
    s_waitcnt vmcnt(3)
    buffer_load_dwordx4 v[100:103], v2, s[28:31], s56 offen offset:3072 nt
    s_add_u32 s56, s56, 32768
    buffer_load_dwordx4 v[104:107], v3, s[32:35], s57 offen
    s_add_u32 s57, s57, s58
    s_cmp_ge_u32 s57, s76
    s_cselect_b32 s57, 0, s57
    v_dot2c_f32_bf16_dpp v8, v30, v88 row_newbcast:8 row_mask:0xf bank_mask:0xf
    v_dot2c_f32_bf16_dpp v10, v30, v89 row_newbcast:8 row_mask:0xf bank_mask:0xf
    v_dot2c_f32_bf16_dpp v12, v30, v90 row_newbcast:8 row_mask:0xf bank_mask:0xf
    v_dot2c_f32_bf16_dpp v14, v30, v91 row_newbcast:8 row_mask:0xf bank_mask:0xf
    v_dot2c_f32_bf16_dpp v9, v31, v88 row_newbcast:8 row_mask:0xf bank_mask:0xf
    v_dot2c_f32_bf16_dpp v11, v31, v89 row_newbcast:8 row_mask:0xf bank_mask:0xf
    v_dot2c_f32_bf16_dpp v13, v31, v90 row_newbcast:8 row_mask:0xf bank_mask:0xf
    v_dot2c_f32_bf16_dpp v15, v31, v91 row_newbcast:8 row_mask:0xf bank_mask:0xf
    v_perm_b32 v224, v229, v225, s77
    v_perm_b32 v229, v229, v225, s61
    s_waitcnt vmcnt(4)
    v_dot2c_f32_bf16_dpp v8, v30, v92 row_newbcast:9 row_mask:0xf bank_mask:0xf
    v_dot2c_f32_bf16_dpp v10, v30, v93 row_newbcast:9 row_mask:0xf bank_mask:0xf
    v_dot2c_f32_bf16_dpp v12, v30, v94 row_newbcast:9 row_mask:0xf bank_mask:0xf
    v_dot2c_f32_bf16_dpp v14, v30, v95 row_newbcast:9 row_mask:0xf bank_mask:0xf
    v_dot2c_f32_bf16_dpp v9, v31, v92 row_newbcast:9 row_mask:0xf bank_mask:0xf
    v_dot2c_f32_bf16_dpp v11, v31, v93 row_newbcast:9 row_mask:0xf bank_mask:0xf
    v_dot2c_f32_bf16_dpp v13, v31, v94 row_newbcast:9 row_mask:0xf bank_mask:0xf
    v_dot2c_f32_bf16_dpp v15, v31, v95 row_newbcast:9 row_mask:0xf bank_mask:0xf
    v_perm_b32 v225, v230, v226, s77
    v_perm_b32 v230, v230, v226, s61
    s_waitcnt vmcnt(3)
    buffer_load_dwordx4 v[108:111], v2, s[28:31], s56 offen nt
    buffer_load_dwordx4 v[112:115], v2, s[28:31], s56 offen offset:1024 nt
    v_dot2c_f32_bf16_dpp v8, v30, v96 row_newbcast:10 row_mask:0xf bank_mask:0xf
    v_dot2c_f32_bf16_dpp v10, v30, v97 row_newbcast:10 row_mask:0xf bank_mask:0xf
    v_dot2c_f32_bf16_dpp v12, v30, v98 row_newbcast:10 row_mask:0xf bank_mask:0xf
    v_dot2c_f32_bf16_dpp v14, v30, v99 row_newbcast:10 row_mask:0xf bank_mask:0xf
    v_dot2c_f32_bf16_dpp v9, v31, v96 row_newbcast:10 row_mask:0xf bank_mask:0xf
    v_dot2c_f32_bf16_dpp v11, v31, v97 row_newbcast:10 row_mask:0xf bank_mask:0xf
    v_dot2c_f32_bf16_dpp v13, v31, v98 row_newbcast:10 row_mask:0xf bank_mask:0xf
    v_dot2c_f32_bf16_dpp v15, v31, v99 row_newbcast:10 row_mask:0xf bank_mask:0xf
    v_perm_b32 v226, v231, v227, s77
    v_perm_b32 v231, v231, v227, s61
    s_waitcnt vmcnt(3)
    buffer_load_dwordx4 v[236:239], v4, s[36:39], s60 offen
    s_add_u32 s60, s60, 8192
    s_and_b32 s60, s60, 262143
    v_dot2c_f32_bf16_dpp v8, v30, v100 row_newbcast:11 row_mask:0xf bank_mask:0xf
    v_dot2c_f32_bf16_dpp v10, v30, v101 row_newbcast:11 row_mask:0xf bank_mask:0xf
    v_dot2c_f32_bf16_dpp v12, v30, v102 row_newbcast:11 row_mask:0xf bank_mask:0xf
    v_dot2c_f32_bf16_dpp v14, v30, v103 row_newbcast:11 row_mask:0xf bank_mask:0xf
    v_dot2c_f32_bf16_dpp v9, v31, v100 row_newbcast:11 row_mask:0xf bank_mask:0xf
    v_dot2c_f32_bf16_dpp v11, v31, v101 row_newbcast:11 row_mask:0xf bank_mask:0xf
    v_dot2c_f32_bf16_dpp v13, v31, v102 row_newbcast:11 row_mask:0xf bank_mask:0xf
    v_dot2c_f32_bf16_dpp v15, v31, v103 row_newbcast:11 row_mask:0xf bank_mask:0xf
    s_waitcnt vmcnt(3)
    buffer_load_dwordx4 v[116:119], v2, s[28:31], s56 offen offset:2048 nt
    buffer_load_dwordx4 v[120:123], v2, s[28:31], s56 offen offset:3072 nt
    s_add_u32 s56, s56, 32768
    v_dot2c_f32_bf16_dpp v16, v28, v104 row_newbcast:2 row_mask:0xf bank_mask:0xf
    v_dot2c_f32_bf16_dpp v18, v28, v105 row_newbcast:2 row_mask:0xf bank_mask:0xf
    v_dot2c_f32_bf16_dpp v20, v28, v106 row_newbcast:2 row_mask:0xf bank_mask:0xf
    v_dot2c_f32_bf16_dpp v22, v28, v107 row_newbcast:2 row_mask:0xf bank_mask:0xf
    v_dot2c_f32_bf16_dpp v17, v29, v104 row_newbcast:2 row_mask:0xf bank_mask:0xf
    v_dot2c_f32_bf16_dpp v19, v29, v105 row_newbcast:2 row_mask:0xf bank_mask:0xf
    v_dot2c_f32_bf16_dpp v21, v29, v106 row_newbcast:2 row_mask:0xf bank_mask:0xf
    v_dot2c_f32_bf16_dpp v23, v29, v107 row_newbcast:2 row_mask:0xf bank_mask:0xf
    s_waitcnt vmcnt(4)
    v_dot2c_f32_bf16_dpp v8, v30, v108 row_newbcast:12 row_mask:0xf bank_mask:0xf
    v_dot2c_f32_bf16_dpp v10, v30, v109 row_newbcast:12 row_mask:0xf bank_mask:0xf
    v_dot2c_f32_bf16_dpp v12, v30, v110 row_newbcast:12 row_mask:0xf bank_mask:0xf
    v_dot2c_f32_bf16_dpp v14, v30, v111 row_newbcast:12 row_mask:0xf bank_mask:0xf
    v_dot2c_f32_bf16_dpp v9, v31, v108 row_newbcast:12 row_mask:0xf bank_mask:0xf
    v_dot2c_f32_bf16_dpp v11, v31, v109 row_newbcast:12 row_mask:0xf bank_mask:0xf
    v_dot2c_f32_bf16_dpp v13, v31, v110 row_newbcast:12 row_mask:0xf bank_mask:0xf
    v_dot2c_f32_bf16_dpp v15, v31, v111 row_newbcast:12 row_mask:0xf bank_mask:0xf
    s_waitcnt vmcnt(3)
    buffer_load_dwordx4 v[124:127], v3, s[32:35], s57 offen
    s_add_u32 s57, s57, s58
    s_cmp_ge_u32 s57, s76
    s_cselect_b32 s57, 0, s57
    buffer_load_dwordx4 v[48:51], v2, s[28:31], s56 offen nt
    v_dot2c_f32_bf16_dpp v8, v30, v112 row_newbcast:13 row_mask:0xf bank_mask:0xf
    v_dot2c_f32_bf16_dpp v10, v30, v113 row_newbcast:13 row_mask:0xf bank_mask:0xf
    v_dot2c_f32_bf16_dpp v12, v30, v114 row_newbcast:13 row_mask:0xf bank_mask:0xf
    v_dot2c_f32_bf16_dpp v14, v30, v115 row_newbcast:13 row_mask:0xf bank_mask:0xf
    v_dot2c_f32_bf16_dpp v9, v31, v112 row_newbcast:13 row_mask:0xf bank_mask:0xf
    v_dot2c_f32_bf16_dpp v11, v31, v113 row_newbcast:13 row_mask:0xf bank_mask:0xf
    v_dot2c_f32_bf16_dpp v13, v31, v114 row_newbcast:13 row_mask:0xf bank_mask:0xf
    v_dot2c_f32_bf16_dpp v15, v31, v115 row_newbcast:13 row_mask:0xf bank_mask:0xf
    s_waitcnt vmcnt(3)
    buffer_load_dwordx4 v[240:243], v4, s[36:39], s60 offen
    s_add_u32 s60, s60, 8192
    s_and_b32 s60, s60, 262143
    v_dot2c_f32_bf16_dpp v8, v30, v116 row_newbcast:14 row_mask:0xf bank_mask:0xf
    v_dot2c_f32_bf16_dpp v10, v30, v117 row_newbcast:14 row_mask:0xf bank_mask:0xf
    v_dot2c_f32_bf16_dpp v12, v30, v118 row_newbcast:14 row_mask:0xf bank_mask:0xf
    v_dot2c_f32_bf16_dpp v14, v30, v119 row_newbcast:14 row_mask:0xf bank_mask:0xf
    v_dot2c_f32_bf16_dpp v9, v31, v116 row_newbcast:14 row_mask:0xf bank_mask:0xf
    v_dot2c_f32_bf16_dpp v11, v31, v117 row_newbcast:14 row_mask:0xf bank_mask:0xf
    v_dot2c_f32_bf16_dpp v13, v31, v118 row_newbcast:14 row_mask:0xf bank_mask:0xf
    v_dot2c_f32_bf16_dpp v15, v31, v119 row_newbcast:14 row_mask:0xf bank_mask:0xf
    v_perm_b32 v227, v236, v232, s77
    v_perm_b32 v236, v236, v232, s61
    s_waitcnt vmcnt(3)
    buffer_load_dwordx4 v[52:55], v2, s[28:31], s56 offen offset:1024 nt
    buffer_load_dwordx4 v[56:59], v2, s[28:31], s56 offen offset:2048 nt
    v_dot2c_f32_bf16_dpp v8, v30, v120 row_newbcast:15 row_mask:0xf bank_mask:0xf
    v_dot2c_f32_bf16_dpp v10, v30, v121 row_newbcast:15 row_mask:0xf bank_mask:0xf
    v_dot2c_f32_bf16_dpp v12, v30, v122 row_newbcast:15 row_mask:0xf bank_mask:0xf
    v_dot2c_f32_bf16_dpp v14, v30, v123 row_newbcast:15 row_mask:0xf bank_mask:0xf
    v_dot2c_f32_bf16_dpp v9, v31, v120 row_newbcast:15 row_mask:0xf bank_mask:0xf
    v_dot2c_f32_bf16_dpp v11, v31, v121 row_newbcast:15 row_mask:0xf bank_mask:0xf
    v_dot2c_f32_bf16_dpp v13, v31, v122 row_newbcast:15 row_mask:0xf bank_mask:0xf
    v_dot2c_f32_bf16_dpp v15, v31, v123 row_newbcast:15 row_mask:0xf bank_mask:0xf
    v_perm_b32 v232, v237, v233, s77
    v_perm_b32 v237, v237, v233, s61
    s_waitcnt vmcnt(4)
    buffer_load_dwordx4 v[60:63], v2, s[28:31], s56 offen offset:3072 nt
    s_add_u32 s56, s56, 32768
    v_dot2c_f32_bf16_dpp v16, v28, v124 row_newbcast:3 row_mask:0xf bank_mask:0xf
    v_dot2c_f32_bf16_dpp v18, v28, v125 row_newbcast:3 row_mask:0xf bank_mask:0xf
    v_dot2c_f32_bf16_dpp v20, v28, v126 row_newbcast:3 row_mask:0xf bank_mask:0xf
    v_dot2c_f32_bf16_dpp v22, v28, v127 row_newbcast:3 row_mask:0xf bank_mask:0xf
    v_dot2c_f32_bf16_dpp v17, v29, v124 row_newbcast:3 row_mask:0xf bank_mask:0xf
    v_dot2c_f32_bf16_dpp v19, v29, v125 row_newbcast:3 row_mask:0xf bank_mask:0xf
    v_dot2c_f32_bf16_dpp v21, v29, v126 row_newbcast:3 row_mask:0xf bank_mask:0xf
    v_dot2c_f32_bf16_dpp v23, v29, v127 row_newbcast:3 row_mask:0xf bank_mask:0xf
    v_perm_b32 v233, v238, v234, s77
    v_perm_b32 v238, v238, v234, s61
    s_barrier
    s_waitcnt lgkmcnt(0)
    ds_read_b32 v30, v5
    ds_read_b32 v28, v6
    v_add_u32 v5, 256, v5
    v_add_u32 v6, 64, v6
    v_and_or_b32 v6, v6, s95, v1
    s_waitcnt lgkmcnt(0)
    v_lshlrev_b32 v31, 16, v30
    v_lshlrev_b32 v29, 16, v28
    s_waitcnt vmcnt(4)
    buffer_load_dwordx4 v[64:67], v3, s[32:35], s57 offen
    s_add_u32 s57, s57, s58
    s_cmp_ge_u32 s57, s76
    s_cselect_b32 s57, 0, s57
    v_dot2c_f32_bf16_dpp v8, v30, v48 row_newbcast:0 row_mask:0xf bank_mask:0xf
    v_dot2c_f32_bf16_dpp v10, v30, v49 row_newbcast:0 row_mask:0xf bank_mask:0xf
    v_dot2c_f32_bf16_dpp v12, v30, v50 row_newbcast:0 row_mask:0xf bank_mask:0xf
    v_dot2c_f32_bf16_dpp v14, v30, v51 row_newbcast:0 row_mask:0xf bank_mask:0xf
    v_dot2c_f32_bf16_dpp v9, v31, v48 row_newbcast:0 row_mask:0xf bank_mask:0xf
    v_dot2c_f32_bf16_dpp v11, v31, v49 row_newbcast:0 row_mask:0xf bank_mask:0xf
    v_dot2c_f32_bf16_dpp v13, v31, v50 row_newbcast:0 row_mask:0xf bank_mask:0xf
    v_dot2c_f32_bf16_dpp v15, v31, v51 row_newbcast:0 row_mask:0xf bank_mask:0xf
    v_perm_b32 v234, v239, v235, s77
    v_perm_b32 v239, v239, v235, s61
    s_waitcnt vmcnt(3)
    buffer_load_dwordx4 v[244:247], v4, s[36:39], s60 offen
    s_add_u32 s60, s60, 8192
    s_and_b32 s60, s60, 262143
    v_dot2c_f32_bf16_dpp v8, v30, v52 row_newbcast:1 row_mask:0xf bank_mask:0xf
    v_dot2c_f32_bf16_dpp v10, v30, v53 row_newbcast:1 row_mask:0xf bank_mask:0xf
    v_dot2c_f32_bf16_dpp v12, v30, v54 row_newbcast:1 row_mask:0xf bank_mask:0xf
    v_dot2c_f32_bf16_dpp v14, v30, v55 row_newbcast:1 row_mask:0xf bank_mask:0xf
    v_dot2c_f32_bf16_dpp v9, v31, v52 row_newbcast:1 row_mask:0xf bank_mask:0xf
    v_dot2c_f32_bf16_dpp v11, v31, v53 row_newbcast:1 row_mask:0xf bank_mask:0xf
    v_dot2c_f32_bf16_dpp v13, v31, v54 row_newbcast:1 row_mask:0xf bank_mask:0xf
    v_dot2c_f32_bf16_dpp v15, v31, v55 row_newbcast:1 row_mask:0xf bank_mask:0xf
    s_waitcnt vmcnt(3)
    buffer_load_dwordx4 v[68:71], v2, s[28:31], s56 offen nt
    buffer_load_dwordx4 v[72:75], v2, s[28:31], s56 offen offset:1024 nt
    v_dot2c_f32_bf16_dpp v8, v30, v56 row_newbcast:2 row_mask:0xf bank_mask:0xf
    v_dot2c_f32_bf16_dpp v10, v30, v57 row_newbcast:2 row_mask:0xf bank_mask:0xf
    v_dot2c_f32_bf16_dpp v12, v30, v58 row_newbcast:2 row_mask:0xf bank_mask:0xf
    v_dot2c_f32_bf16_dpp v14, v30, v59 row_newbcast:2 row_mask:0xf bank_mask:0xf
    v_dot2c_f32_bf16_dpp v9, v31, v56 row_newbcast:2 row_mask:0xf bank_mask:0xf
    v_dot2c_f32_bf16_dpp v11, v31, v57 row_newbcast:2 row_mask:0xf bank_mask:0xf
    v_dot2c_f32_bf16_dpp v13, v31, v58 row_newbcast:2 row_mask:0xf bank_mask:0xf
    v_dot2c_f32_bf16_dpp v15, v31, v59 row_newbcast:2 row_mask:0xf bank_mask:0xf
    s_waitcnt vmcnt(4)
    v_dot2c_f32_bf16_dpp v8, v30, v60 row_newbcast:3 row_mask:0xf bank_mask:0xf
    v_dot2c_f32_bf16_dpp v10, v30, v61 row_newbcast:3 row_mask:0xf bank_mask:0xf
    v_dot2c_f32_bf16_dpp v12, v30, v62 row_newbcast:3 row_mask:0xf bank_mask:0xf
    v_dot2c_f32_bf16_dpp v14, v30, v63 row_newbcast:3 row_mask:0xf bank_mask:0xf
    v_dot2c_f32_bf16_dpp v9, v31, v60 row_newbcast:3 row_mask:0xf bank_mask:0xf
    v_dot2c_f32_bf16_dpp v11, v31, v61 row_newbcast:3 row_mask:0xf bank_mask:0xf
    v_dot2c_f32_bf16_dpp v13, v31, v62 row_newbcast:3 row_mask:0xf bank_mask:0xf
    v_dot2c_f32_bf16_dpp v15, v31, v63 row_newbcast:3 row_mask:0xf bank_mask:0xf
    s_waitcnt vmcnt(3)
    buffer_load_dwordx4 v[76:79], v2, s[28:31], s56 offen offset:2048 nt
    buffer_load_dwordx4 v[80:83], v2, s[28:31], s56 offen offset:3072 nt
    s_add_u32 s56, s56, 32768
    v_dot2c_f32_bf16_dpp v16, v28, v64 row_newbcast:0 row_mask:0xf bank_mask:0xf
    v_dot2c_f32_bf16_dpp v18, v28, v65 row_newbcast:0 row_mask:0xf bank_mask:0xf
    v_dot2c_f32_bf16_dpp v20, v28, v66 row_newbcast:0 row_mask:0xf bank_mask:0xf
    v_dot2c_f32_bf16_dpp v22, v28, v67 row_newbcast:0 row_mask:0xf bank_mask:0xf
    v_dot2c_f32_bf16_dpp v17, v29, v64 row_newbcast:0 row_mask:0xf bank_mask:0xf
    v_dot2c_f32_bf16_dpp v19, v29, v65 row_newbcast:0 row_mask:0xf bank_mask:0xf
    v_dot2c_f32_bf16_dpp v21, v29, v66 row_newbcast:0 row_mask:0xf bank_mask:0xf
    v_dot2c_f32_bf16_dpp v23, v29, v67 row_newbcast:0 row_mask:0xf bank_mask:0xf
    s_waitcnt vmcnt(3)
    buffer_load_dwordx4 v[248:251], v4, s[36:39], s60 offen
    s_add_u32 s60, s60, 8192
    s_and_b32 s60, s60, 262143
    v_dot2c_f32_bf16_dpp v8, v30, v68 row_newbcast:4 row_mask:0xf bank_mask:0xf
    v_dot2c_f32_bf16_dpp v10, v30, v69 row_newbcast:4 row_mask:0xf bank_mask:0xf
    v_dot2c_f32_bf16_dpp v12, v30, v70 row_newbcast:4 row_mask:0xf bank_mask:0xf
    v_dot2c_f32_bf16_dpp v14, v30, v71 row_newbcast:4 row_mask:0xf bank_mask:0xf
    v_dot2c_f32_bf16_dpp v9, v31, v68 row_newbcast:4 row_mask:0xf bank_mask:0xf
    v_dot2c_f32_bf16_dpp v11, v31, v69 row_newbcast:4 row_mask:0xf bank_mask:0xf
    v_dot2c_f32_bf16_dpp v13, v31, v70 row_newbcast:4 row_mask:0xf bank_mask:0xf
    v_dot2c_f32_bf16_dpp v15, v31, v71 row_newbcast:4 row_mask:0xf bank_mask:0xf
    v_perm_b32 v235, v244, v240, s77
    v_perm_b32 v244, v244, v240, s61
    s_waitcnt vmcnt(3)
    buffer_load_dwordx4 v[84:87], v3, s[32:35], s57 offen
    s_add_u32 s57, s57, s58
    s_cmp_ge_u32 s57, s76
    s_cselect_b32 s57, 0, s57
    buffer_load_dwordx4 v[88:91], v2, s[28:31], s56 offen nt
    v_dot2c_f32_bf16_dpp v8, v30, v72 row_newbcast:5 row_mask:0xf bank_mask:0xf
    v_dot2c_f32_bf16_dpp v10, v30, v73 row_newbcast:5 row_mask:0xf bank_mask:0xf
    v_dot2c_f32_bf16_dpp v12, v30, v74 row_newbcast:5 row_mask:0xf bank_mask:0xf
    v_dot2c_f32_bf16_dpp v14, v30, v75 row_newbcast:5 row_mask:0xf bank_mask:0xf
    v_dot2c_f32_bf16_dpp v9, v31, v72 row_newbcast:5 row_mask:0xf bank_mask:0xf
    v_dot2c_f32_bf16_dpp v11, v31, v73 row_newbcast:5 row_mask:0xf bank_mask:0xf
    v_dot2c_f32_bf16_dpp v13, v31, v74 row_newbcast:5 row_mask:0xf bank_mask:0xf
    v_dot2c_f32_bf16_dpp v15, v31, v75 row_newbcast:5 row_mask:0xf bank_mask:0xf
    v_perm_b32 v240, v245, v241, s77
    v_perm_b32 v245, v245, v241, s61
    s_waitcnt vmcnt(4)
    v_dot2c_f32_bf16_dpp v8, v30, v76 row_newbcast:6 row_mask:0xf bank_mask:0xf
    v_dot2c_f32_bf16_dpp v10, v30, v77 row_newbcast:6 row_mask:0xf bank_mask:0xf
    v_dot2c_f32_bf16_dpp v12, v30, v78 row_newbcast:6 row_mask:0xf bank_mask:0xf
    v_dot2c_f32_bf16_dpp v14, v30, v79 row_newbcast:6 row_mask:0xf bank_mask:0xf
    v_dot2c_f32_bf16_dpp v9, v31, v76 row_newbcast:6 row_mask:0xf bank_mask:0xf
    v_dot2c_f32_bf16_dpp v11, v31, v77 row_newbcast:6 row_mask:0xf bank_mask:0xf
    v_dot2c_f32_bf16_dpp v13, v31, v78 row_newbcast:6 row_mask:0xf bank_mask:0xf
    v_dot2c_f32_bf16_dpp v15, v31, v79 row_newbcast:6 row_mask:0xf bank_mask:0xf
    v_perm_b32 v241, v246, v242, s77
    v_perm_b32 v246, v246, v242, s61
    s_waitcnt vmcnt(3)
    buffer_load_dwordx4 v[92:95], v2, s[28:31], s56 offen offset:1024 nt
    buffer_load_dwordx4 v[96:99], v2, s[28:31], s56 offen offset:2048 nt
    v_dot2c_f32_bf16_dpp v8, v30, v80 row_newbcast:7 row_mask:0xf bank_mask:0xf
    v_dot2c_f32_bf16_dpp v10, v30, v81 row_newbcast:7 row_mask:0xf bank_mask:0xf
    v_dot2c_f32_bf16_dpp v12, v30, v82 row_newbcast:7 row_mask:0xf bank_mask:0xf
    v_dot2c_f32_bf16_dpp v14, v30, v83 row_newbcast:7 row_mask:0xf bank_mask:0xf
    v_dot2c_f32_bf16_dpp v9, v31, v80 row_newbcast:7 row_mask:0xf bank_mask:0xf
    v_dot2c_f32_bf16_dpp v11, v31, v81 row_newbcast:7 row_mask:0xf bank_mask:0xf
    v_dot2c_f32_bf16_dpp v13, v31, v82 row_newbcast:7 row_mask:0xf bank_mask:0xf
    v_dot2c_f32_bf16_dpp v15, v31, v83 row_newbcast:7 row_mask:0xf bank_mask:0xf
    v_perm_b32 v242, v247, v243, s77
    v_perm_b32 v247, v247, v243, s61
    s_waitcnt vmcnt(3)
    buffer_load_dwordx4 v[252:255], v4, s[36:39], s60 offen
    s_add_u32 s60, s60, 8192
    s_and_b32 s60, s60, 262143
    v_dot2c_f32_bf16_dpp v16, v28, v84 row_newbcast:1 row_mask:0xf bank_mask:0xf
    v_dot2c_f32_bf16_dpp v18, v28, v85 row_newbcast:1 row_mask:0xf bank_mask:0xf
    v_dot2c_f32_bf16_dpp v20, v28, v86 row_newbcast:1 row_mask:0xf bank_mask:0xf
    v_dot2c_f32_bf16_dpp v22, v28, v87 row_newbcast:1 row_mask:0xf bank_mask:0xf
    v_dot2c_f32_bf16_dpp v17, v29, v84 row_newbcast:1 row_mask:0xf bank_mask:0xf
    v_dot2c_f32_bf16_dpp v19, v29, v85 row_newbcast:1 row_mask:0xf bank_mask:0xf
    v_dot2c_f32_bf16_dpp v21, v29, v86 row_newbcast:1 row_mask:0xf bank_mask:0xf
    v_dot2c_f32_bf16_dpp v23, v29, v87 row_newbcast:1 row_mask:0xf bank_mask:0xf
    s_waitcnt vmcnt(3)
    buffer_load_dwordx4 v[100:103], v2, s[28:31], s56 offen offset:3072 nt
    s_add_u32 s56, s56, 32768
    buffer_load_dwordx4 v[104:107], v3, s[32:35], s57 offen
    s_add_u32 s57, s57, s58
    s_cmp_ge_u32 s57, s76
    s_cselect_b32 s57, 0, s57
    v_dot2c_f32_bf16_dpp v8, v30, v88 row_newbcast:8 row_mask:0xf bank_mask:0xf
    v_dot2c_f32_bf16_dpp v10, v30, v89 row_newbcast:8 row_mask:0xf bank_mask:0xf
    v_dot2c_f32_bf16_dpp v12, v30, v90 row_newbcast:8 row_mask:0xf bank_mask:0xf
    v_dot2c_f32_bf16_dpp v14, v30, v91 row_newbcast:8 row_mask:0xf bank_mask:0xf
    v_dot2c_f32_bf16_dpp v9, v31, v88 row_newbcast:8 row_mask:0xf bank_mask:0xf
    v_dot2c_f32_bf16_dpp v11, v31, v89 row_newbcast:8 row_mask:0xf bank_mask:0xf
    v_dot2c_f32_bf16_dpp v13, v31, v90 row_newbcast:8 row_mask:0xf bank_mask:0xf
    v_dot2c_f32_bf16_dpp v15, v31, v91 row_newbcast:8 row_mask:0xf bank_mask:0xf
    s_waitcnt vmcnt(4)
    v_dot2c_f32_bf16_dpp v8, v30, v92 row_newbcast:9 row_mask:0xf bank_mask:0xf
    v_dot2c_f32_bf16_dpp v10, v30, v93 row_newbcast:9 row_mask:0xf bank_mask:0xf
    v_dot2c_f32_bf16_dpp v12, v30, v94 row_newbcast:9 row_mask:0xf bank_mask:0xf
    v_dot2c_f32_bf16_dpp v14, v30, v95 row_newbcast:9 row_mask:0xf bank_mask:0xf
    v_dot2c_f32_bf16_dpp v9, v31, v92 row_newbcast:9 row_mask:0xf bank_mask:0xf
    v_dot2c_f32_bf16_dpp v11, v31, v93 row_newbcast:9 row_mask:0xf bank_mask:0xf
    v_dot2c_f32_bf16_dpp v13, v31, v94 row_newbcast:9 row_mask:0xf bank_mask:0xf
    v_dot2c_f32_bf16_dpp v15, v31, v95 row_newbcast:9 row_mask:0xf bank_mask:0xf
    s_waitcnt vmcnt(3)
    buffer_load_dwordx4 v[108:111], v2, s[28:31], s56 offen nt
    buffer_load_dwordx4 v[112:115], v2, s[28:31], s56 offen offset:1024 nt
    v_dot2c_f32_bf16_dpp v8, v30, v96 row_newbcast:10 row_mask:0xf bank_mask:0xf
    v_dot2c_f32_bf16_dpp v10, v30, v97 row_newbcast:10 row_mask:0xf bank_mask:0xf
    v_dot2c_f32_bf16_dpp v12, v30, v98 row_newbcast:10 row_mask:0xf bank_mask:0xf
    v_dot2c_f32_bf16_dpp v14, v30, v99 row_newbcast:10 row_mask:0xf bank_mask:0xf
    v_dot2c_f32_bf16_dpp v9, v31, v96 row_newbcast:10 row_mask:0xf bank_mask:0xf
    v_dot2c_f32_bf16_dpp v11, v31, v97 row_newbcast:10 row_mask:0xf bank_mask:0xf
    v_dot2c_f32_bf16_dpp v13, v31, v98 row_newbcast:10 row_mask:0xf bank_mask:0xf
    v_dot2c_f32_bf16_dpp v15, v31, v99 row_newbcast:10 row_mask:0xf bank_mask:0xf
    s_waitcnt vmcnt(3)
    v_dot2c_f32_bf16_dpp v8, v30, v100 row_newbcast:11 row_mask:0xf bank_mask:0xf
    v_dot2c_f32_bf16_dpp v10, v30, v101 row_newbcast:11 row_mask:0xf bank_mask:0xf
    v_dot2c_f32_bf16_dpp v12, v30, v102 row_newbcast:11 row_mask:0xf bank_mask:0xf
    v_dot2c_f32_bf16_dpp v14, v30, v103 row_newbcast:11 row_mask:0xf bank_mask:0xf
    v_dot2c_f32_bf16_dpp v9, v31, v100 row_newbcast:11 row_mask:0xf bank_mask:0xf
    v_dot2c_f32_bf16_dpp v11, v31, v101 row_newbcast:11 row_mask:0xf bank_mask:0xf
    v_dot2c_f32_bf16_dpp v13, v31, v102 row_newbcast:11 row_mask:0xf bank_mask:0xf
    v_dot2c_f32_bf16_dpp v15, v31, v103 row_newbcast:11 row_mask:0xf bank_mask:0xf
    v_perm_b32 v243, v252, v248, s77
    v_perm_b32 v252, v252, v248, s61
    s_waitcnt vmcnt(2)
    buffer_load_dwordx4 v[116:119], v2, s[28:31], s56 offen offset:2048 nt
    buffer_load_dwordx4 v[120:123], v2, s[28:31], s56 offen offset:3072 nt
    s_add_u32 s56, s56, 32768
    v_dot2c_f32_bf16_dpp v16, v28, v104 row_newbcast:2 row_mask:0xf bank_mask:0xf
    v_dot2c_f32_bf16_dpp v18, v28, v105 row_newbcast:2 row_mask:0xf bank_mask:0xf
    v_dot2c_f32_bf16_dpp v20, v28, v106 row_newbcast:2 row_mask:0xf bank_mask:0xf
    v_dot2c_f32_bf16_dpp v22, v28, v107 row_newbcast:2 row_mask:0xf bank_mask:0xf
    v_dot2c_f32_bf16_dpp v17, v29, v104 row_newbcast:2 row_mask:0xf bank_mask:0xf
    v_dot2c_f32_bf16_dpp v19, v29, v105 row_newbcast:2 row_mask:0xf bank_mask:0xf
    v_dot2c_f32_bf16_dpp v21, v29, v106 row_newbcast:2 row_mask:0xf bank_mask:0xf
    v_dot2c_f32_bf16_dpp v23, v29, v107 row_newbcast:2 row_mask:0xf bank_mask:0xf
    v_perm_b32 v248, v253, v249, s77
    v_perm_b32 v253, v253, v249, s61
    s_waitcnt vmcnt(3)
    v_dot2c_f32_bf16_dpp v8, v30, v108 row_newbcast:12 row_mask:0xf bank_mask:0xf
    v_dot2c_f32_bf16_dpp v10, v30, v109 row_newbcast:12 row_mask:0xf bank_mask:0xf
    v_dot2c_f32_bf16_dpp v12, v30, v110 row_newbcast:12 row_mask:0xf bank_mask:0xf
    v_dot2c_f32_bf16_dpp v14, v30, v111 row_newbcast:12 row_mask:0xf bank_mask:0xf
    v_dot2c_f32_bf16_dpp v9, v31, v108 row_newbcast:12 row_mask:0xf bank_mask:0xf
    v_dot2c_f32_bf16_dpp v11, v31, v109 row_newbcast:12 row_mask:0xf bank_mask:0xf
    v_dot2c_f32_bf16_dpp v13, v31, v110 row_newbcast:12 row_mask:0xf bank_mask:0xf
    v_dot2c_f32_bf16_dpp v15, v31, v111 row_newbcast:12 row_mask:0xf bank_mask:0xf
    v_perm_b32 v249, v254, v250, s77
    v_perm_b32 v254, v254, v250, s61
    s_waitcnt vmcnt(2)
    buffer_load_dwordx4 v[124:127], v3, s[32:35], s57 offen
    s_add_u32 s57, s57, s58
    s_cmp_ge_u32 s57, s76
    s_cselect_b32 s57, 0, s57
    buffer_load_dwordx4 v[48:51], v2, s[28:31], s56 offen nt
    v_dot2c_f32_bf16_dpp v8, v30, v112 row_newbcast:13 row_mask:0xf bank_mask:0xf
    v_dot2c_f32_bf16_dpp v10, v30, v113 row_newbcast:13 row_mask:0xf bank_mask:0xf
    v_dot2c_f32_bf16_dpp v12, v30, v114 row_newbcast:13 row_mask:0xf bank_mask:0xf
    v_dot2c_f32_bf16_dpp v14, v30, v115 row_newbcast:13 row_mask:0xf bank_mask:0xf
    v_dot2c_f32_bf16_dpp v9, v31, v112 row_newbcast:13 row_mask:0xf bank_mask:0xf
    v_dot2c_f32_bf16_dpp v11, v31, v113 row_newbcast:13 row_mask:0xf bank_mask:0xf
    v_dot2c_f32_bf16_dpp v13, v31, v114 row_newbcast:13 row_mask:0xf bank_mask:0xf
    v_dot2c_f32_bf16_dpp v15, v31, v115 row_newbcast:13 row_mask:0xf bank_mask:0xf
    v_perm_b32 v250, v255, v251, s77
    v_perm_b32 v255, v255, v251, s61
    s_waitcnt vmcnt(3)
    v_dot2c_f32_bf16_dpp v8, v30, v116 row_newbcast:14 row_mask:0xf bank_mask:0xf
    v_dot2c_f32_bf16_dpp v10, v30, v117 row_newbcast:14 row_mask:0xf bank_mask:0xf
    v_dot2c_f32_bf16_dpp v12, v30, v118 row_newbcast:14 row_mask:0xf bank_mask:0xf
    v_dot2c_f32_bf16_dpp v14, v30, v119 row_newbcast:14 row_mask:0xf bank_mask:0xf
    v_dot2c_f32_bf16_dpp v9, v31, v116 row_newbcast:14 row_mask:0xf bank_mask:0xf
    v_dot2c_f32_bf16_dpp v11, v31, v117 row_newbcast:14 row_mask:0xf bank_mask:0xf
    v_dot2c_f32_bf16_dpp v13, v31, v118 row_newbcast:14 row_mask:0xf bank_mask:0xf
    v_dot2c_f32_bf16_dpp v15, v31, v119 row_newbcast:14 row_mask:0xf bank_mask:0xf
    s_waitcnt vmcnt(2)
    buffer_load_dwordx4 v[52:55], v2, s[28:31], s56 offen offset:1024 nt
    buffer_load_dwordx4 v[56:59], v2, s[28:31], s56 offen offset:2048 nt
    v_dot2c_f32_bf16_dpp v8, v30, v120 row_newbcast:15 row_mask:0xf bank_mask:0xf
    v_dot2c_f32_bf16_dpp v10, v30, v121 row_newbcast:15 row_mask:0xf bank_mask:0xf
    v_dot2c_f32_bf16_dpp v12, v30, v122 row_newbcast:15 row_mask:0xf bank_mask:0xf
    v_dot2c_f32_bf16_dpp v14, v30, v123 row_newbcast:15 row_mask:0xf bank_mask:0xf
    v_dot2c_f32_bf16_dpp v9, v31, v120 row_newbcast:15 row_mask:0xf bank_mask:0xf
    v_dot2c_f32_bf16_dpp v11, v31, v121 row_newbcast:15 row_mask:0xf bank_mask:0xf
    v_dot2c_f32_bf16_dpp v13, v31, v122 row_newbcast:15 row_mask:0xf bank_mask:0xf
    v_dot2c_f32_bf16_dpp v15, v31, v123 row_newbcast:15 row_mask:0xf bank_mask:0xf
    s_waitcnt vmcnt(3)
    buffer_load_dwordx4 v[60:63], v2, s[28:31], s56 offen offset:3072 nt
    s_add_u32 s56, s56, 32768
    v_dot2c_f32_bf16_dpp v16, v28, v124 row_newbcast:3 row_mask:0xf bank_mask:0xf
    v_dot2c_f32_bf16_dpp v18, v28, v125 row_newbcast:3 row_mask:0xf bank_mask:0xf
    v_dot2c_f32_bf16_dpp v20, v28, v126 row_newbcast:3 row_mask:0xf bank_mask:0xf
    v_dot2c_f32_bf16_dpp v22, v28, v127 row_newbcast:3 row_mask:0xf bank_mask:0xf
    v_dot2c_f32_bf16_dpp v17, v29, v124 row_newbcast:3 row_mask:0xf bank_mask:0xf
    v_dot2c_f32_bf16_dpp v19, v29, v125 row_newbcast:3 row_mask:0xf bank_mask:0xf
    v_dot2c_f32_bf16_dpp v21, v29, v126 row_newbcast:3 row_mask:0xf bank_mask:0xf
    v_dot2c_f32_bf16_dpp v23, v29, v127 row_newbcast:3 row_mask:0xf bank_mask:0xf
    s_barrier
    s_waitcnt lgkmcnt(0)
    ds_read_b32 v30, v5
    ds_read_b32 v28, v6
    v_add_u32 v5, 256, v5
    v_add_u32 v6, 64, v6
    v_and_or_b32 v6, v6, s95, v1
    s_waitcnt lgkmcnt(0)
    v_lshlrev_b32 v31, 16, v30
    v_lshlrev_b32 v29, 16, v28
    s_waitcnt vmcnt(3)
    buffer_load_dwordx4 v[68:71], v2, s[28:31], s56 offen nt
    v_dot2c_f32_bf16_dpp v8, v30, v48 row_newbcast:0 row_mask:0xf bank_mask:0xf
    v_dot2c_f32_bf16_dpp v10, v30, v49 row_newbcast:0 row_mask:0xf bank_mask:0xf
    v_dot2c_f32_bf16_dpp v12, v30, v50 row_newbcast:0 row_mask:0xf bank_mask:0xf
    v_dot2c_f32_bf16_dpp v14, v30, v51 row_newbcast:0 row_mask:0xf bank_mask:0xf
    v_dot2c_f32_bf16_dpp v9, v31, v48 row_newbcast:0 row_mask:0xf bank_mask:0xf
    v_dot2c_f32_bf16_dpp v11, v31, v49 row_newbcast:0 row_mask:0xf bank_mask:0xf
    v_dot2c_f32_bf16_dpp v13, v31, v50 row_newbcast:0 row_mask:0xf bank_mask:0xf
    v_dot2c_f32_bf16_dpp v15, v31, v51 row_newbcast:0 row_mask:0xf bank_mask:0xf
    s_waitcnt vmcnt(3)
    buffer_load_dwordx4 v[72:75], v2, s[28:31], s56 offen offset:1024 nt
    v_dot2c_f32_bf16_dpp v8, v30, v52 row_newbcast:1 row_mask:0xf bank_mask:0xf
    v_dot2c_f32_bf16_dpp v10, v30, v53 row_newbcast:1 row_mask:0xf bank_mask:0xf
    v_dot2c_f32_bf16_dpp v12, v30, v54 row_newbcast:1 row_mask:0xf bank_mask:0xf
    v_dot2c_f32_bf16_dpp v14, v30, v55 row_newbcast:1 row_mask:0xf bank_mask:0xf
    v_dot2c_f32_bf16_dpp v9, v31, v52 row_newbcast:1 row_mask:0xf bank_mask:0xf
    v_dot2c_f32_bf16_dpp v11, v31, v53 row_newbcast:1 row_mask:0xf bank_mask:0xf
    v_dot2c_f32_bf16_dpp v13, v31, v54 row_newbcast:1 row_mask:0xf bank_mask:0xf
    v_dot2c_f32_bf16_dpp v15, v31, v55 row_newbcast:1 row_mask:0xf bank_mask:0xf
    s_waitcnt vmcnt(3)
    buffer_load_dwordx4 v[76:79], v2, s[28:31], s56 offen offset:2048 nt
    v_dot2c_f32_bf16_dpp v8, v30, v56 row_newbcast:2 row_mask:0xf bank_mask:0xf
    v_dot2c_f32_bf16_dpp v10, v30, v57 row_newbcast:2 row_mask:0xf bank_mask:0xf
    v_dot2c_f32_bf16_dpp v12, v30, v58 row_newbcast:2 row_mask:0xf bank_mask:0xf
    v_dot2c_f32_bf16_dpp v14, v30, v59 row_newbcast:2 row_mask:0xf bank_mask:0xf
    v_dot2c_f32_bf16_dpp v9, v31, v56 row_newbcast:2 row_mask:0xf bank_mask:0xf
    v_dot2c_f32_bf16_dpp v11, v31, v57 row_newbcast:2 row_mask:0xf bank_mask:0xf
    v_dot2c_f32_bf16_dpp v13, v31, v58 row_newbcast:2 row_mask:0xf bank_mask:0xf
    v_dot2c_f32_bf16_dpp v15, v31, v59 row_newbcast:2 row_mask:0xf bank_mask:0xf
    s_waitcnt vmcnt(3)
    buffer_load_dwordx4 v[80:83], v2, s[28:31], s56 offen offset:3072 nt
    s_add_u32 s56, s56, 32768
    v_dot2c_f32_bf16_dpp v8, v30, v60 row_newbcast:3 row_mask:0xf bank_mask:0xf
    v_dot2c_f32_bf16_dpp v10, v30, v61 row_newbcast:3 row_mask:0xf bank_mask:0xf
    v_dot2c_f32_bf16_dpp v12, v30, v62 row_newbcast:3 row_mask:0xf bank_mask:0xf
    v_dot2c_f32_bf16_dpp v14, v30, v63 row_newbcast:3 row_mask:0xf bank_mask:0xf
    v_dot2c_f32_bf16_dpp v9, v31, v60 row_newbcast:3 row_mask:0xf bank_mask:0xf
    v_dot2c_f32_bf16_dpp v11, v31, v61 row_newbcast:3 row_mask:0xf bank_mask:0xf
    v_dot2c_f32_bf16_dpp v13, v31, v62 row_newbcast:3 row_mask:0xf bank_mask:0xf
    v_dot2c_f32_bf16_dpp v15, v31, v63 row_newbcast:3 row_mask:0xf bank_mask:0xf
    s_waitcnt vmcnt(3)
    buffer_load_dwordx4 v[88:91], v2, s[28:31], s56 offen nt
    v_dot2c_f32_bf16_dpp v8, v30, v68 row_newbcast:4 row_mask:0xf bank_mask:0xf
    v_dot2c_f32_bf16_dpp v10, v30, v69 row_newbcast:4 row_mask:0xf bank_mask:0xf
    v_dot2c_f32_bf16_dpp v12, v30, v70 row_newbcast:4 row_mask:0xf bank_mask:0xf
    v_dot2c_f32_bf16_dpp v14, v30, v71 row_newbcast:4 row_mask:0xf bank_mask:0xf
    v_dot2c_f32_bf16_dpp v9, v31, v68 row_newbcast:4 row_mask:0xf bank_mask:0xf
    v_dot2c_f32_bf16_dpp v11, v31, v69 row_newbcast:4 row_mask:0xf bank_mask:0xf
    v_dot2c_f32_bf16_dpp v13, v31, v70 row_newbcast:4 row_mask:0xf bank_mask:0xf
    v_dot2c_f32_bf16_dpp v15, v31, v71 row_newbcast:4 row_mask:0xf bank_mask:0xf
    s_waitcnt vmcnt(3)
    buffer_load_dwordx4 v[92:95], v2, s[28:31], s56 offen offset:1024 nt
    v_dot2c_f32_bf16_dpp v8, v30, v72 row_newbcast:5 row_mask:0xf bank_mask:0xf
    v_dot2c_f32_bf16_dpp v10, v30, v73 row_newbcast:5 row_mask:0xf bank_mask:0xf
    v_dot2c_f32_bf16_dpp v12, v30, v74 row_newbcast:5 row_mask:0xf bank_mask:0xf
    v_dot2c_f32_bf16_dpp v14, v30, v75 row_newbcast:5 row_mask:0xf bank_mask:0xf
    v_dot2c_f32_bf16_dpp v9, v31, v72 row_newbcast:5 row_mask:0xf bank_mask:0xf
    v_dot2c_f32_bf16_dpp v11, v31, v73 row_newbcast:5 row_mask:0xf bank_mask:0xf
    v_dot2c_f32_bf16_dpp v13, v31, v74 row_newbcast:5 row_mask:0xf bank_mask:0xf
    v_dot2c_f32_bf16_dpp v15, v31, v75 row_newbcast:5 row_mask:0xf bank_mask:0xf
    s_waitcnt vmcnt(3)
    buffer_load_dwordx4 v[96:99], v2, s[28:31], s56 offen offset:2048 nt
    v_dot2c_f32_bf16_dpp v8, v30, v76 row_newbcast:6 row_mask:0xf bank_mask:0xf
    v_dot2c_f32_bf16_dpp v10, v30, v77 row_newbcast:6 row_mask:0xf bank_mask:0xf
    v_dot2c_f32_bf16_dpp v12, v30, v78 row_newbcast:6 row_mask:0xf bank_mask:0xf
    v_dot2c_f32_bf16_dpp v14, v30, v79 row_newbcast:6 row_mask:0xf bank_mask:0xf
    v_dot2c_f32_bf16_dpp v9, v31, v76 row_newbcast:6 row_mask:0xf bank_mask:0xf
    v_dot2c_f32_bf16_dpp v11, v31, v77 row_newbcast:6 row_mask:0xf bank_mask:0xf
    v_dot2c_f32_bf16_dpp v13, v31, v78 row_newbcast:6 row_mask:0xf bank_mask:0xf
    v_dot2c_f32_bf16_dpp v15, v31, v79 row_newbcast:6 row_mask:0xf bank_mask:0xf
    s_waitcnt vmcnt(3)
    buffer_load_dwordx4 v[100:103], v2, s[28:31], s56 offen offset:3072 nt
    s_add_u32 s56, s56, 32768
    v_dot2c_f32_bf16_dpp v8, v30, v80 row_newbcast:7 row_mask:0xf bank_mask:0xf
    v_dot2c_f32_bf16_dpp v10, v30, v81 row_newbcast:7 row_mask:0xf bank_mask:0xf
    v_dot2c_f32_bf16_dpp v12, v30, v82 row_newbcast:7 row_mask:0xf bank_mask:0xf
    v_dot2c_f32_bf16_dpp v14, v30, v83 row_newbcast:7 row_mask:0xf bank_mask:0xf
    v_dot2c_f32_bf16_dpp v9, v31, v80 row_newbcast:7 row_mask:0xf bank_mask:0xf
    v_dot2c_f32_bf16_dpp v11, v31, v81 row_newbcast:7 row_mask:0xf bank_mask:0xf
    v_dot2c_f32_bf16_dpp v13, v31, v82 row_newbcast:7 row_mask:0xf bank_mask:0xf
    v_dot2c_f32_bf16_dpp v15, v31, v83 row_newbcast:7 row_mask:0xf bank_mask:0xf
    s_waitcnt vmcnt(3)
    buffer_load_dwordx4 v[108:111], v2, s[28:31], s56 offen nt
    v_dot2c_f32_bf16_dpp v8, v30, v88 row_newbcast:8 row_mask:0xf bank_mask:0xf
    v_dot2c_f32_bf16_dpp v10, v30, v89 row_newbcast:8 row_mask:0xf bank_mask:0xf
    v_dot2c_f32_bf16_dpp v12, v30, v90 row_newbcast:8 row_mask:0xf bank_mask:0xf
    v_dot2c_f32_bf16_dpp v14, v30, v91 row_newbcast:8 row_mask:0xf bank_mask:0xf
    v_dot2c_f32_bf16_dpp v9, v31, v88 row_newbcast:8 row_mask:0xf bank_mask:0xf
    v_dot2c_f32_bf16_dpp v11, v31, v89 row_newbcast:8 row_mask:0xf bank_mask:0xf
    v_dot2c_f32_bf16_dpp v13, v31, v90 row_newbcast:8 row_mask:0xf bank_mask:0xf
    v_dot2c_f32_bf16_dpp v15, v31, v91 row_newbcast:8 row_mask:0xf bank_mask:0xf
    s_waitcnt vmcnt(3)
    buffer_load_dwordx4 v[112:115], v2, s[28:31], s56 offen offset:1024 nt
    v_dot2c_f32_bf16_dpp v8, v30, v92 row_newbcast:9 row_mask:0xf bank_mask:0xf
    v_dot2c_f32_bf16_dpp v10, v30, v93 row_newbcast:9 row_mask:0xf bank_mask:0xf
    v_dot2c_f32_bf16_dpp v12, v30, v94 row_newbcast:9 row_mask:0xf bank_mask:0xf
    v_dot2c_f32_bf16_dpp v14, v30, v95 row_newbcast:9 row_mask:0xf bank_mask:0xf
    v_dot2c_f32_bf16_dpp v9, v31, v92 row_newbcast:9 row_mask:0xf bank_mask:0xf
    v_dot2c_f32_bf16_dpp v11, v31, v93 row_newbcast:9 row_mask:0xf bank_mask:0xf
    v_dot2c_f32_bf16_dpp v13, v31, v94 row_newbcast:9 row_mask:0xf bank_mask:0xf
    v_dot2c_f32_bf16_dpp v15, v31, v95 row_newbcast:9 row_mask:0xf bank_mask:0xf
    s_waitcnt vmcnt(3)
    buffer_load_dwordx4 v[116:119], v2, s[28:31], s56 offen offset:2048 nt
    v_dot2c_f32_bf16_dpp v8, v30, v96 row_newbcast:10 row_mask:0xf bank_mask:0xf
    v_dot2c_f32_bf16_dpp v10, v30, v97 row_newbcast:10 row_mask:0xf bank_mask:0xf
    v_dot2c_f32_bf16_dpp v12, v30, v98 row_newbcast:10 row_mask:0xf bank_mask:0xf
    v_dot2c_f32_bf16_dpp v14, v30, v99 row_newbcast:10 row_mask:0xf bank_mask:0xf
    v_dot2c_f32_bf16_dpp v9, v31, v96 row_newbcast:10 row_mask:0xf bank_mask:0xf
    v_dot2c_f32_bf16_dpp v11, v31, v97 row_newbcast:10 row_mask:0xf bank_mask:0xf
    v_dot2c_f32_bf16_dpp v13, v31, v98 row_newbcast:10 row_mask:0xf bank_mask:0xf
    v_dot2c_f32_bf16_dpp v15, v31, v99 row_newbcast:10 row_mask:0xf bank_mask:0xf
    s_waitcnt vmcnt(3)
    buffer_load_dwordx4 v[120:123], v2, s[28:31], s56 offen offset:3072 nt
    s_add_u32 s56, s56, 32768
    v_dot2c_f32_bf16_dpp v8, v30, v100 row_newbcast:11 row_mask:0xf bank_mask:0xf
    v_dot2c_f32_bf16_dpp v10, v30, v101 row_newbcast:11 row_mask:0xf bank_mask:0xf
    v_dot2c_f32_bf16_dpp v12, v30, v102 row_newbcast:11 row_mask:0xf bank_mask:0xf
    v_dot2c_f32_bf16_dpp v14, v30, v103 row_newbcast:11 row_mask:0xf bank_mask:0xf
    v_dot2c_f32_bf16_dpp v9, v31, v100 row_newbcast:11 row_mask:0xf bank_mask:0xf
    v_dot2c_f32_bf16_dpp v11, v31, v101 row_newbcast:11 row_mask:0xf bank_mask:0xf
    v_dot2c_f32_bf16_dpp v13, v31, v102 row_newbcast:11 row_mask:0xf bank_mask:0xf
    v_dot2c_f32_bf16_dpp v15, v31, v103 row_newbcast:11 row_mask:0xf bank_mask:0xf
    s_waitcnt vmcnt(3)
    buffer_load_dwordx4 v[64:67], v3, s[32:35], s57 offen
    s_add_u32 s57, s57, s58
    s_cmp_ge_u32 s57, s76
    s_cselect_b32 s57, 0, s57
    v_dot2c_f32_bf16_dpp v8, v30, v108 row_newbcast:12 row_mask:0xf bank_mask:0xf
    v_dot2c_f32_bf16_dpp v10, v30, v109 row_newbcast:12 row_mask:0xf bank_mask:0xf
    v_dot2c_f32_bf16_dpp v12, v30, v110 row_newbcast:12 row_mask:0xf bank_mask:0xf
    v_dot2c_f32_bf16_dpp v14, v30, v111 row_newbcast:12 row_mask:0xf bank_mask:0xf
    v_dot2c_f32_bf16_dpp v9, v31, v108 row_newbcast:12 row_mask:0xf bank_mask:0xf
    v_dot2c_f32_bf16_dpp v11, v31, v109 row_newbcast:12 row_mask:0xf bank_mask:0xf
    v_dot2c_f32_bf16_dpp v13, v31, v110 row_newbcast:12 row_mask:0xf bank_mask:0xf
    v_dot2c_f32_bf16_dpp v15, v31, v111 row_newbcast:12 row_mask:0xf bank_mask:0xf
    s_waitcnt vmcnt(3)
    buffer_load_dwordx4 v[84:87], v3, s[32:35], s57 offen
    s_add_u32 s57, s57, s58
    s_cmp_ge_u32 s57, s76
    s_cselect_b32 s57, 0, s57
    v_dot2c_f32_bf16_dpp v8, v30, v112 row_newbcast:13 row_mask:0xf bank_mask:0xf
    v_dot2c_f32_bf16_dpp v10, v30, v113 row_newbcast:13 row_mask:0xf bank_mask:0xf
    v_dot2c_f32_bf16_dpp v12, v30, v114 row_newbcast:13 row_mask:0xf bank_mask:0xf
    v_dot2c_f32_bf16_dpp v14, v30, v115 row_newbcast:13 row_mask:0xf bank_mask:0xf
    v_dot2c_f32_bf16_dpp v9, v31, v112 row_newbcast:13 row_mask:0xf bank_mask:0xf
    v_dot2c_f32_bf16_dpp v11, v31, v113 row_newbcast:13 row_mask:0xf bank_mask:0xf
    v_dot2c_f32_bf16_dpp v13, v31, v114 row_newbcast:13 row_mask:0xf bank_mask:0xf
    v_dot2c_f32_bf16_dpp v15, v31, v115 row_newbcast:13 row_mask:0xf bank_mask:0xf
    s_waitcnt vmcnt(3)
    buffer_load_dwordx4 v[104:107], v3, s[32:35], s57 offen
    s_add_u32 s57, s57, s58
    s_cmp_ge_u32 s57, s76
    s_cselect_b32 s57, 0, s57
    v_dot2c_f32_bf16_dpp v8, v30, v116 row_newbcast:14 row_mask:0xf bank_mask:0xf
    v_dot2c_f32_bf16_dpp v10, v30, v117 row_newbcast:14 row_mask:0xf bank_mask:0xf
    v_dot2c_f32_bf16_dpp v12, v30, v118 row_newbcast:14 row_mask:0xf bank_mask:0xf
    v_dot2c_f32_bf16_dpp v14, v30, v119 row_newbcast:14 row_mask:0xf bank_mask:0xf
    v_dot2c_f32_bf16_dpp v9, v31, v116 row_newbcast:14 row_mask:0xf bank_mask:0xf
    v_dot2c_f32_bf16_dpp v11, v31, v117 row_newbcast:14 row_mask:0xf bank_mask:0xf
    v_dot2c_f32_bf16_dpp v13, v31, v118 row_newbcast:14 row_mask:0xf bank_mask:0xf
    v_dot2c_f32_bf16_dpp v15, v31, v119 row_newbcast:14 row_mask:0xf bank_mask:0xf
    s_waitcnt vmcnt(3)
    buffer_load_dwordx4 v[124:127], v3, s[32:35], s57 offen
    s_add_u32 s57, s57, s58
    s_cmp_ge_u32 s57, s76
    s_cselect_b32 s57, 0, s57
    v_dot2c_f32_bf16_dpp v8, v30, v120 row_newbcast:15 row_mask:0xf bank_mask:0xf
    v_dot2c_f32_bf16_dpp v10, v30, v121 row_newbcast:15 row_mask:0xf bank_mask:0xf
    v_dot2c_f32_bf16_dpp v12, v30, v122 row_newbcast:15 row_mask:0xf bank_mask:0xf
    v_dot2c_f32_bf16_dpp v14, v30, v123 row_newbcast:15 row_mask:0xf bank_mask:0xf
    v_dot2c_f32_bf16_dpp v9, v31, v120 row_newbcast:15 row_mask:0xf bank_mask:0xf
    v_dot2c_f32_bf16_dpp v11, v31, v121 row_newbcast:15 row_mask:0xf bank_mask:0xf
    v_dot2c_f32_bf16_dpp v13, v31, v122 row_newbcast:15 row_mask:0xf bank_mask:0xf
    v_dot2c_f32_bf16_dpp v15, v31, v123 row_newbcast:15 row_mask:0xf bank_mask:0xf
    s_nop 2
    v_permlane32_swap_b32 v8, v12
    v_permlane32_swap_b32 v9, v13
    v_permlane32_swap_b32 v10, v14
    v_permlane32_swap_b32 v11, v15
    v_add_f32 v8, v8, v12
    v_add_f32 v9, v9, v13
    v_add_f32 v10, v10, v14
    v_add_f32 v11, v11, v15
    s_nop 1
    v_permlane16_swap_b32 v8, v10
    v_permlane16_swap_b32 v9, v11
    v_add_f32 v8, v8, v10
    v_add_f32 v9, v9, v11
    ds_write_b64 v45, v[8:9] offset:28672
    s_mul_i32 s74, s26, 2
    v_add_u32 v42, s74, v39
    v_and_b32 v42, 15, v42
    v_lshl_add_u32 v42, v42, 3, v38
    v_lshlrev_b32 v42, 2, v42
    v_mov_b32 v8, 0
    v_mov_b32 v9, 0
    v_mov_b32 v10, 0
    v_mov_b32 v11, 0
    v_mov_b32 v12, 0
    v_mov_b32 v13, 0
    v_mov_b32 v14, 0
    v_mov_b32 v15, 0
    v_lshlrev_b32 v43, 2, v0
    v_add_u32 v46, s72, v43
    v_add_u32 v46, 37120, v46
    s_lshl_b32 s73, s26, 12
    s_add_u32 s73, s73, s72
    v_add_u32 v68, 28672, v42
    v_add_u32 v69, 29184, v42
    v_add_u32 v70, 29696, v42
    v_add_u32 v71, 30208, v42
    v_add_u32 v72, 30720, v42
    v_add_u32 v73, 31232, v42
    v_add_u32 v74, 31744, v42
    v_add_u32 v75, 32256, v42
    s_waitcnt lgkmcnt(0)
    s_barrier
    ds_read2_b32 v[48:49], v68 offset0:0 offset1:4
    ds_read2_b32 v[50:51], v69 offset0:0 offset1:4
    ds_read2_b32 v[52:53], v70 offset0:0 offset1:4
    ds_read2_b32 v[54:55], v71 offset0:0 offset1:4
    ds_read2_b32 v[56:57], v72 offset0:0 offset1:4
    ds_read2_b32 v[58:59], v73 offset0:0 offset1:4
    ds_read2_b32 v[60:61], v74 offset0:0 offset1:4
    ds_read2_b32 v[62:63], v75 offset0:0 offset1:4
    s_waitcnt lgkmcnt(0)
    v_add_f32 v48, v48, v56
    v_add_f32 v49, v49, v57
    v_add_f32 v50, v50, v58
    v_add_f32 v51, v51, v59
    v_add_f32 v52, v52, v60
    v_add_f32 v53, v53, v61
    v_add_f32 v54, v54, v62
    v_add_f32 v55, v55, v63
    v_add_f32 v48, v48, v52
    v_add_f32 v49, v49, v53
    v_add_f32 v50, v50, v54
    v_add_f32 v51, v51, v55
    v_add_f32 v48, v48, v50
    v_add_f32 v49, v49, v51
    v_cvt_pk_bf16_f32 v34, v48, v49
    s_nop 1
    v_dot2c_f32_bf16_dpp v8, v34, v33 row_newbcast:0 row_mask:0xf bank_mask:0xf
    v_dot2c_f32_bf16_dpp v9, v34, v132 row_newbcast:0 row_mask:0xf bank_mask:0xf
    v_dot2c_f32_bf16_dpp v10, v34, v128 row_newbcast:0 row_mask:0xf bank_mask:0xf
    v_dot2c_f32_bf16_dpp v11, v34, v133 row_newbcast:0 row_mask:0xf bank_mask:0xf
    v_dot2c_f32_bf16_dpp v12, v34, v129 row_newbcast:0 row_mask:0xf bank_mask:0xf
    v_dot2c_f32_bf16_dpp v13, v34, v134 row_newbcast:0 row_mask:0xf bank_mask:0xf
    v_dot2c_f32_bf16_dpp v14, v34, v130 row_newbcast:0 row_mask:0xf bank_mask:0xf
    v_dot2c_f32_bf16_dpp v15, v34, v135 row_newbcast:0 row_mask:0xf bank_mask:0xf
    v_dot2c_f32_bf16_dpp v8, v34, v131 row_newbcast:1 row_mask:0xf bank_mask:0xf
    v_dot2c_f32_bf16_dpp v9, v34, v140 row_newbcast:1 row_mask:0xf bank_mask:0xf
    v_dot2c_f32_bf16_dpp v10, v34, v136 row_newbcast:1 row_mask:0xf bank_mask:0xf
    v_dot2c_f32_bf16_dpp v11, v34, v141 row_newbcast:1 row_mask:0xf bank_mask:0xf
    v_dot2c_f32_bf16_dpp v12, v34, v137 row_newbcast:1 row_mask:0xf bank_mask:0xf
    v_dot2c_f32_bf16_dpp v13, v34, v142 row_newbcast:1 row_mask:0xf bank_mask:0xf
    v_dot2c_f32_bf16_dpp v14, v34, v138 row_newbcast:1 row_mask:0xf bank_mask:0xf
    v_dot2c_f32_bf16_dpp v15, v34, v143 row_newbcast:1 row_mask:0xf bank_mask:0xf
    v_dot2c_f32_bf16_dpp v8, v34, v139 row_newbcast:2 row_mask:0xf bank_mask:0xf
    v_dot2c_f32_bf16_dpp v9, v34, v148 row_newbcast:2 row_mask:0xf bank_mask:0xf
    v_dot2c_f32_bf16_dpp v10, v34, v144 row_newbcast:2 row_mask:0xf bank_mask:0xf
    v_dot2c_f32_bf16_dpp v11, v34, v149 row_newbcast:2 row_mask:0xf bank_mask:0xf
    v_dot2c_f32_bf16_dpp v12, v34, v145 row_newbcast:2 row_mask:0xf bank_mask:0xf
    v_dot2c_f32_bf16_dpp v13, v34, v150 row_newbcast:2 row_mask:0xf bank_mask:0xf
    v_dot2c_f32_bf16_dpp v14, v34, v146 row_newbcast:2 row_mask:0xf bank_mask:0xf
    v_dot2c_f32_bf16_dpp v15, v34, v151 row_newbcast:2 row_mask:0xf bank_mask:0xf
    v_dot2c_f32_bf16_dpp v8, v34, v147 row_newbcast:3 row_mask:0xf bank_mask:0xf
    v_dot2c_f32_bf16_dpp v9, v34, v156 row_newbcast:3 row_mask:0xf bank_mask:0xf
    v_dot2c_f32_bf16_dpp v10, v34, v152 row_newbcast:3 row_mask:0xf bank_mask:0xf
    v_dot2c_f32_bf16_dpp v11, v34, v157 row_newbcast:3 row_mask:0xf bank_mask:0xf
    v_dot2c_f32_bf16_dpp v12, v34, v153 row_newbcast:3 row_mask:0xf bank_mask:0xf
    v_dot2c_f32_bf16_dpp v13, v34, v158 row_newbcast:3 row_mask:0xf bank_mask:0xf
    v_dot2c_f32_bf16_dpp v14, v34, v154 row_newbcast:3 row_mask:0xf bank_mask:0xf
    v_dot2c_f32_bf16_dpp v15, v34, v159 row_newbcast:3 row_mask:0xf bank_mask:0xf
    v_dot2c_f32_bf16_dpp v8, v34, v155 row_newbcast:4 row_mask:0xf bank_mask:0xf
    v_dot2c_f32_bf16_dpp v9, v34, v164 row_newbcast:4 row_mask:0xf bank_mask:0xf
    v_dot2c_f32_bf16_dpp v10, v34, v160 row_newbcast:4 row_mask:0xf bank_mask:0xf
    v_dot2c_f32_bf16_dpp v11, v34, v165 row_newbcast:4 row_mask:0xf bank_mask:0xf
    v_dot2c_f32_bf16_dpp v12, v34, v161 row_newbcast:4 row_mask:0xf bank_mask:0xf
    v_dot2c_f32_bf16_dpp v13, v34, v166 row_newbcast:4 row_mask:0xf bank_mask:0xf
    v_dot2c_f32_bf16_dpp v14, v34, v162 row_newbcast:4 row_mask:0xf bank_mask:0xf
    v_dot2c_f32_bf16_dpp v15, v34, v167 row_newbcast:4 row_mask:0xf bank_mask:0xf
    v_dot2c_f32_bf16_dpp v8, v34, v163 row_newbcast:5 row_mask:0xf bank_mask:0xf
    v_dot2c_f32_bf16_dpp v9, v34, v172 row_newbcast:5 row_mask:0xf bank_mask:0xf
    v_dot2c_f32_bf16_dpp v10, v34, v168 row_newbcast:5 row_mask:0xf bank_mask:0xf
    v_dot2c_f32_bf16_dpp v11, v34, v173 row_newbcast:5 row_mask:0xf bank_mask:0xf
    v_dot2c_f32_bf16_dpp v12, v34, v169 row_newbcast:5 row_mask:0xf bank_mask:0xf
    v_dot2c_f32_bf16_dpp v13, v34, v174 row_newbcast:5 row_mask:0xf bank_mask:0xf
    v_dot2c_f32_bf16_dpp v14, v34, v170 row_newbcast:5 row_mask:0xf bank_mask:0xf
    v_dot2c_f32_bf16_dpp v15, v34, v175 row_newbcast:5 row_mask:0xf bank_mask:0xf
    v_dot2c_f32_bf16_dpp v8, v34, v171 row_newbcast:6 row_mask:0xf bank_mask:0xf
    v_dot2c_f32_bf16_dpp v9, v34, v180 row_newbcast:6 row_mask:0xf bank_mask:0xf
    v_dot2c_f32_bf16_dpp v10, v34, v176 row_newbcast:6 row_mask:0xf bank_mask:0xf
    v_dot2c_f32_bf16_dpp v11, v34, v181 row_newbcast:6 row_mask:0xf bank_mask:0xf
    v_dot2c_f32_bf16_dpp v12, v34, v177 row_newbcast:6 row_mask:0xf bank_mask:0xf
    v_dot2c_f32_bf16_dpp v13, v34, v182 row_newbcast:6 row_mask:0xf bank_mask:0xf
    v_dot2c_f32_bf16_dpp v14, v34, v178 row_newbcast:6 row_mask:0xf bank_mask:0xf
    v_dot2c_f32_bf16_dpp v15, v34, v183 row_newbcast:6 row_mask:0xf bank_mask:0xf
    v_dot2c_f32_bf16_dpp v8, v34, v179 row_newbcast:7 row_mask:0xf bank_mask:0xf
    v_dot2c_f32_bf16_dpp v9, v34, v188 row_newbcast:7 row_mask:0xf bank_mask:0xf
    v_dot2c_f32_bf16_dpp v10, v34, v184 row_newbcast:7 row_mask:0xf bank_mask:0xf
    v_dot2c_f32_bf16_dpp v11, v34, v189 row_newbcast:7 row_mask:0xf bank_mask:0xf
    v_dot2c_f32_bf16_dpp v12, v34, v185 row_newbcast:7 row_mask:0xf bank_mask:0xf
    v_dot2c_f32_bf16_dpp v13, v34, v190 row_newbcast:7 row_mask:0xf bank_mask:0xf
    v_dot2c_f32_bf16_dpp v14, v34, v186 row_newbcast:7 row_mask:0xf bank_mask:0xf
    v_dot2c_f32_bf16_dpp v15, v34, v191 row_newbcast:7 row_mask:0xf bank_mask:0xf
    v_dot2c_f32_bf16_dpp v8, v34, v187 row_newbcast:8 row_mask:0xf bank_mask:0xf
    v_dot2c_f32_bf16_dpp v9, v34, v196 row_newbcast:8 row_mask:0xf bank_mask:0xf
    v_dot2c_f32_bf16_dpp v10, v34, v192 row_newbcast:8 row_mask:0xf bank_mask:0xf
    v_dot2c_f32_bf16_dpp v11, v34, v197 row_newbcast:8 row_mask:0xf bank_mask:0xf
    v_dot2c_f32_bf16_dpp v12, v34, v193 row_newbcast:8 row_mask:0xf bank_mask:0xf
    v_dot2c_f32_bf16_dpp v13, v34, v198 row_newbcast:8 row_mask:0xf bank_mask:0xf
    v_dot2c_f32_bf16_dpp v14, v34, v194 row_newbcast:8 row_mask:0xf bank_mask:0xf
    v_dot2c_f32_bf16_dpp v15, v34, v199 row_newbcast:8 row_mask:0xf bank_mask:0xf
    v_dot2c_f32_bf16_dpp v8, v34, v195 row_newbcast:9 row_mask:0xf bank_mask:0xf
    v_dot2c_f32_bf16_dpp v9, v34, v204 row_newbcast:9 row_mask:0xf bank_mask:0xf
    v_dot2c_f32_bf16_dpp v10, v34, v200 row_newbcast:9 row_mask:0xf bank_mask:0xf
    v_dot2c_f32_bf16_dpp v11, v34, v205 row_newbcast:9 row_mask:0xf bank_mask:0xf
    v_dot2c_f32_bf16_dpp v12, v34, v201 row_newbcast:9 row_mask:0xf bank_mask:0xf
    v_dot2c_f32_bf16_dpp v13, v34, v206 row_newbcast:9 row_mask:0xf bank_mask:0xf
    v_dot2c_f32_bf16_dpp v14, v34, v202 row_newbcast:9 row_mask:0xf bank_mask:0xf
    v_dot2c_f32_bf16_dpp v15, v34, v207 row_newbcast:9 row_mask:0xf bank_mask:0xf
    v_dot2c_f32_bf16_dpp v8, v34, v203 row_newbcast:10 row_mask:0xf bank_mask:0xf
    v_dot2c_f32_bf16_dpp v9, v34, v212 row_newbcast:10 row_mask:0xf bank_mask:0xf
    v_dot2c_f32_bf16_dpp v10, v34, v208 row_newbcast:10 row_mask:0xf bank_mask:0xf
    v_dot2c_f32_bf16_dpp v11, v34, v213 row_newbcast:10 row_mask:0xf bank_mask:0xf
    v_dot2c_f32_bf16_dpp v12, v34, v209 row_newbcast:10 row_mask:0xf bank_mask:0xf
    v_dot2c_f32_bf16_dpp v13, v34, v214 row_newbcast:10 row_mask:0xf bank_mask:0xf
    v_dot2c_f32_bf16_dpp v14, v34, v210 row_newbcast:10 row_mask:0xf bank_mask:0xf
    v_dot2c_f32_bf16_dpp v15, v34, v215 row_newbcast:10 row_mask:0xf bank_mask:0xf
    v_dot2c_f32_bf16_dpp v8, v34, v211 row_newbcast:11 row_mask:0xf bank_mask:0xf
    v_dot2c_f32_bf16_dpp v9, v34, v220 row_newbcast:11 row_mask:0xf bank_mask:0xf
    v_dot2c_f32_bf16_dpp v10, v34, v216 row_newbcast:11 row_mask:0xf bank_mask:0xf
    v_dot2c_f32_bf16_dpp v11, v34, v221 row_newbcast:11 row_mask:0xf bank_mask:0xf
    v_dot2c_f32_bf16_dpp v12, v34, v217 row_newbcast:11 row_mask:0xf bank_mask:0xf
    v_dot2c_f32_bf16_dpp v13, v34, v222 row_newbcast:11 row_mask:0xf bank_mask:0xf
    v_dot2c_f32_bf16_dpp v14, v34, v218 row_newbcast:11 row_mask:0xf bank_mask:0xf
    v_dot2c_f32_bf16_dpp v15, v34, v223 row_newbcast:11 row_mask:0xf bank_mask:0xf
    v_dot2c_f32_bf16_dpp v8, v34, v219 row_newbcast:12 row_mask:0xf bank_mask:0xf
    v_dot2c_f32_bf16_dpp v9, v34, v228 row_newbcast:12 row_mask:0xf bank_mask:0xf
    v_dot2c_f32_bf16_dpp v10, v34, v224 row_newbcast:12 row_mask:0xf bank_mask:0xf
    v_dot2c_f32_bf16_dpp v11, v34, v229 row_newbcast:12 row_mask:0xf bank_mask:0xf
    v_dot2c_f32_bf16_dpp v12, v34, v225 row_newbcast:12 row_mask:0xf bank_mask:0xf
    v_dot2c_f32_bf16_dpp v13, v34, v230 row_newbcast:12 row_mask:0xf bank_mask:0xf
    v_dot2c_f32_bf16_dpp v14, v34, v226 row_newbcast:12 row_mask:0xf bank_mask:0xf
    v_dot2c_f32_bf16_dpp v15, v34, v231 row_newbcast:12 row_mask:0xf bank_mask:0xf
    v_dot2c_f32_bf16_dpp v8, v34, v227 row_newbcast:13 row_mask:0xf bank_mask:0xf
    v_dot2c_f32_bf16_dpp v9, v34, v236 row_newbcast:13 row_mask:0xf bank_mask:0xf
    v_dot2c_f32_bf16_dpp v10, v34, v232 row_newbcast:13 row_mask:0xf bank_mask:0xf
    v_dot2c_f32_bf16_dpp v11, v34, v237 row_newbcast:13 row_mask:0xf bank_mask:0xf
    v_dot2c_f32_bf16_dpp v12, v34, v233 row_newbcast:13 row_mask:0xf bank_mask:0xf
    v_dot2c_f32_bf16_dpp v13, v34, v238 row_newbcast:13 row_mask:0xf bank_mask:0xf
    v_dot2c_f32_bf16_dpp v14, v34, v234 row_newbcast:13 row_mask:0xf bank_mask:0xf
    v_dot2c_f32_bf16_dpp v15, v34, v239 row_newbcast:13 row_mask:0xf bank_mask:0xf
    v_dot2c_f32_bf16_dpp v8, v34, v235 row_newbcast:14 row_mask:0xf bank_mask:0xf
    v_dot2c_f32_bf16_dpp v9, v34, v244 row_newbcast:14 row_mask:0xf bank_mask:0xf
    v_dot2c_f32_bf16_dpp v10, v34, v240 row_newbcast:14 row_mask:0xf bank_mask:0xf
    v_dot2c_f32_bf16_dpp v11, v34, v245 row_newbcast:14 row_mask:0xf bank_mask:0xf
    v_dot2c_f32_bf16_dpp v12, v34, v241 row_newbcast:14 row_mask:0xf bank_mask:0xf
    v_dot2c_f32_bf16_dpp v13, v34, v246 row_newbcast:14 row_mask:0xf bank_mask:0xf
    v_dot2c_f32_bf16_dpp v14, v34, v242 row_newbcast:14 row_mask:0xf bank_mask:0xf
    v_dot2c_f32_bf16_dpp v15, v34, v247 row_newbcast:14 row_mask:0xf bank_mask:0xf
    v_dot2c_f32_bf16_dpp v8, v34, v243 row_newbcast:15 row_mask:0xf bank_mask:0xf
    v_dot2c_f32_bf16_dpp v9, v34, v252 row_newbcast:15 row_mask:0xf bank_mask:0xf
    v_dot2c_f32_bf16_dpp v10, v34, v248 row_newbcast:15 row_mask:0xf bank_mask:0xf
    v_dot2c_f32_bf16_dpp v11, v34, v253 row_newbcast:15 row_mask:0xf bank_mask:0xf
    v_dot2c_f32_bf16_dpp v12, v34, v249 row_newbcast:15 row_mask:0xf bank_mask:0xf
    v_dot2c_f32_bf16_dpp v13, v34, v254 row_newbcast:15 row_mask:0xf bank_mask:0xf
    v_dot2c_f32_bf16_dpp v14, v34, v250 row_newbcast:15 row_mask:0xf bank_mask:0xf
    v_dot2c_f32_bf16_dpp v15, v34, v255 row_newbcast:15 row_mask:0xf bank_mask:0xf
    s_waitcnt vmcnt(3)
    v_dot2c_f32_bf16_dpp v16, v28, v64 row_newbcast:0 row_mask:0xf bank_mask:0xf
    v_dot2c_f32_bf16_dpp v18, v28, v65 row_newbcast:0 row_mask:0xf bank_mask:0xf
    v_dot2c_f32_bf16_dpp v20, v28, v66 row_newbcast:0 row_mask:0xf bank_mask:0xf
    v_dot2c_f32_bf16_dpp v22, v28, v67 row_newbcast:0 row_mask:0xf bank_mask:0xf
    v_dot2c_f32_bf16_dpp v17, v29, v64 row_newbcast:0 row_mask:0xf bank_mask:0xf
    v_dot2c_f32_bf16_dpp v19, v29, v65 row_newbcast:0 row_mask:0xf bank_mask:0xf
    v_dot2c_f32_bf16_dpp v21, v29, v66 row_newbcast:0 row_mask:0xf bank_mask:0xf
    v_dot2c_f32_bf16_dpp v23, v29, v67 row_newbcast:0 row_mask:0xf bank_mask:0xf
    s_waitcnt vmcnt(2)
    v_dot2c_f32_bf16_dpp v16, v28, v84 row_newbcast:1 row_mask:0xf bank_mask:0xf
    v_dot2c_f32_bf16_dpp v18, v28, v85 row_newbcast:1 row_mask:0xf bank_mask:0xf
    v_dot2c_f32_bf16_dpp v20, v28, v86 row_newbcast:1 row_mask:0xf bank_mask:0xf
    v_dot2c_f32_bf16_dpp v22, v28, v87 row_newbcast:1 row_mask:0xf bank_mask:0xf
    v_dot2c_f32_bf16_dpp v17, v29, v84 row_newbcast:1 row_mask:0xf bank_mask:0xf
    v_dot2c_f32_bf16_dpp v19, v29, v85 row_newbcast:1 row_mask:0xf bank_mask:0xf
    v_dot2c_f32_bf16_dpp v21, v29, v86 row_newbcast:1 row_mask:0xf bank_mask:0xf
    v_dot2c_f32_bf16_dpp v23, v29, v87 row_newbcast:1 row_mask:0xf bank_mask:0xf
    s_waitcnt vmcnt(1)
    v_dot2c_f32_bf16_dpp v16, v28, v104 row_newbcast:2 row_mask:0xf bank_mask:0xf
    v_dot2c_f32_bf16_dpp v18, v28, v105 row_newbcast:2 row_mask:0xf bank_mask:0xf
    v_dot2c_f32_bf16_dpp v20, v28, v106 row_newbcast:2 row_mask:0xf bank_mask:0xf
    v_dot2c_f32_bf16_dpp v22, v28, v107 row_newbcast:2 row_mask:0xf bank_mask:0xf
    v_dot2c_f32_bf16_dpp v17, v29, v104 row_newbcast:2 row_mask:0xf bank_mask:0xf
    v_dot2c_f32_bf16_dpp v19, v29, v105 row_newbcast:2 row_mask:0xf bank_mask:0xf
    v_dot2c_f32_bf16_dpp v21, v29, v106 row_newbcast:2 row_mask:0xf bank_mask:0xf
    v_dot2c_f32_bf16_dpp v23, v29, v107 row_newbcast:2 row_mask:0xf bank_mask:0xf
    s_waitcnt vmcnt(0)
    v_dot2c_f32_bf16_dpp v16, v28, v124 row_newbcast:3 row_mask:0xf bank_mask:0xf
    v_dot2c_f32_bf16_dpp v18, v28, v125 row_newbcast:3 row_mask:0xf bank_mask:0xf
    v_dot2c_f32_bf16_dpp v20, v28, v126 row_newbcast:3 row_mask:0xf bank_mask:0xf
    v_dot2c_f32_bf16_dpp v22, v28, v127 row_newbcast:3 row_mask:0xf bank_mask:0xf
    v_dot2c_f32_bf16_dpp v17, v29, v124 row_newbcast:3 row_mask:0xf bank_mask:0xf
    v_dot2c_f32_bf16_dpp v19, v29, v125 row_newbcast:3 row_mask:0xf bank_mask:0xf
    v_dot2c_f32_bf16_dpp v21, v29, v126 row_newbcast:3 row_mask:0xf bank_mask:0xf
    v_dot2c_f32_bf16_dpp v23, v29, v127 row_newbcast:3 row_mask:0xf bank_mask:0xf
    s_nop 2
    v_permlane32_swap_b32 v8, v12
    v_permlane32_swap_b32 v9, v13
    v_permlane32_swap_b32 v10, v14
    v_permlane32_swap_b32 v11, v15
    v_add_f32 v8, v8, v12
    v_add_f32 v9, v9, v13
    v_add_f32 v10, v10, v14
    v_add_f32 v11, v11, v15
    s_nop 1
    v_permlane16_swap_b32 v8, v10
    v_permlane16_swap_b32 v9, v11
    v_add_f32 v8, v8, v10
    v_add_f32 v9, v9, v11
    ds_write_b64 v45, v[8:9] offset:37120
    s_nop 2
    v_permlane32_swap_b32 v16, v20
    v_permlane32_swap_b32 v17, v21
    v_permlane32_swap_b32 v18, v22
    v_permlane32_swap_b32 v19, v23
    v_add_f32 v16, v16, v20
    v_add_f32 v17, v17, v21
    v_add_f32 v18, v18, v22
    v_add_f32 v19, v19, v23
    s_nop 1
    v_permlane16_swap_b32 v16, v18
    v_permlane16_swap_b32 v17, v19
    v_add_f32 v16, v16, v18
    v_add_f32 v17, v17, v19
    ds_write_b64 v45, v[16:17] offset:20480
    ds_read2st64_b32 v[8:9], v46 offset0:0 offset1:1
    v_subrev_u32 v46, 16640, v46
    ds_read2st64_b32 v[16:17], v46 offset0:0 offset1:1
    s_add_u32 s74, s73, 32768
    s_cmp_lt_u32 s27, 28
    s_cselect_b32 s74, s74, 4194304
    s_waitcnt lgkmcnt(1)
    buffer_atomic_add_f32 v8, v43, s[48:51], s73 offen
    buffer_atomic_add_f32 v9, v43, s[48:51], s73 offen offset:256
    s_waitcnt lgkmcnt(0)
    buffer_atomic_add_f32 v16, v43, s[48:51], s74 offen
    buffer_atomic_add_f32 v17, v43, s[48:51], s74 offen offset:256
    s_lshl_b32 s75, s26, 10
    s_lshl_b32 s74, s3, 7
    s_add_u32 s75, s75, s74
    s_add_u32 s75, s75, 65536
    v_mov_b32 v38, 1
    v_mov_b32 v39, 0
    v_lshlrev_b32 v40, 3, v0
    s_lshl_b32 s74, s26, 11
    s_add_u32 s52, s20, s74
    s_addc_u32 s53, s21, 0
    s_mov_b32 s54, 2048
    s_mov_b32 s55, 0x20000
    s_waitcnt vmcnt(0)
    s_mov_b64 exec, 1
    buffer_atomic_add v38, v39, s[48:51], s75 offen sc0
    s_mov_b64 exec, -1
    buffer_load_dword v41, v43, s[40:43], s69 offen
    s_waitcnt vmcnt(0)
    v_readfirstlane_b32 s74, v38
    s_cmp_lg_u32 s74, 31
    s_cbranch_scc1 L_fin
    buffer_load_dwordx2 v[48:49], v40, s[48:51], s73 offen sc1
    s_add_u32 s73, s73, 32768
    buffer_load_dwordx2 v[50:51], v40, s[48:51], s73 offen sc1
    v_lshlrev_b32 v42, 16, v41
    v_and_b32 v44, 0xffff0000, v41
    s_waitcnt vmcnt(0)
    v_cvt_pk_bf16_f32 v46, v48, v49
    v_cvt_pk_bf16_f32 v47, v50, v51
    v_lshlrev_b32 v48, 16, v46
    v_and_b32 v49, 0xffff0000, v46
    v_lshlrev_b32 v50, 16, v47
    v_and_b32 v51, 0xffff0000, v47
    v_add_f32 v48, v42, v48
    v_add_f32 v49, v44, v49
    v_cvt_pk_bf16_f32 v46, v48, v49
    v_lshlrev_b32 v48, 16, v46
    v_and_b32 v49, 0xffff0000, v46
    v_add_f32 v48, v48, v50
    v_add_f32 v49, v49, v51
    v_cvt_pk_bf16_f32 v46, v48, v49
    buffer_store_dword v46, v43, s[52:55], s69 offen
    s_cmp_lg_u32 s3, 0
    s_cbranch_scc1 L_fin
    v_mov_b32 v38, s96
    v_mov_b32 v39, s97
    v_mov_b32 v40, 131072
    s_mov_b64 exec, 1
    buffer_store_dwordx2 v[38:39], v40, s[48:51], 0 offen sc0 sc1
    s_mov_b64 exec, -1
L_fin:
L_done:
    s_endpgm
.section .rodata,"a"
.p2align 6
.amdhsa_kernel parallel_sum__mha_block_cached__dense_activation_relu__decode_kernel
  .amdhsa_next_free_vgpr 256
  .amdhsa_next_free_sgpr 100
  .amdhsa_accum_offset 256
  .amdhsa_group_segment_fixed_size 0
  .amdhsa_kernarg_size 88
  .amdhsa_user_sgpr_count 2
  .amdhsa_user_sgpr_kernarg_segment_ptr 1
  .amdhsa_system_sgpr_workgroup_id_x 1
  .amdhsa_float_denorm_mode_32 3
.end_amdhsa_kernel
```
